```python
import torch

def _softmax(x, axis=-1):
    return torch.softmax(x, dim=axis)
def _gelu(x):
    return torch.nn.functional.gelu(x, approximate="tanh")
def _silu(x):
    return torch.nn.functional.silu(x)
def _sigmoid(x):
    return torch.sigmoid(x)
def _layernorm(x, axis=-1, eps=1e-5):
    m = x.mean(dim=axis, keepdim=True)
    v = x.var(dim=axis, keepdim=True, unbiased=False)
    return (x - m) / torch.sqrt(v + eps)
def _scatter_add(tgt, idx, src, axis=0):
    return tgt.clone().index_add_(axis, idx, src)
def _segment_sum(src, seg, n):
    out = torch.zeros((n,) + src.shape[1:], dtype=src.dtype)
    return out.index_add_(0, seg, src)
def _pad(x, pw):
    flat = tuple(v for pair in reversed(pw) for v in pair)
    return torch.nn.functional.pad(x, flat)

kernel_name = 'gated_mix__mha_block__mha_block__prompt'

def setup_inputs():

    _w = (lambda a: (lambda t: t.to(torch.bfloat16) if t.is_floating_point() else t)(torch.as_tensor(a)))
    def _A_setup():
        B, S, D, H = 1, 2048, 512, 32
        return {
            "x": _w((lambda *s: torch.randn(*s, dtype=torch.bfloat16) * 0.05)(B, S, D)),
            "wqkv": _w((lambda *s: torch.randn(*s, dtype=torch.bfloat16) * 0.8)(D, 3 * D)),
            "wo": _w((lambda *s: torch.randn(*s, dtype=torch.bfloat16) * 0.05)(D, D)),
        }
    _A_in = _A_setup()

    def _B_setup():
        B, S, D, H = 1, 2048, 512, 32
        return {
            "x": _w((lambda *s: torch.randn(*s, dtype=torch.bfloat16) * 0.05)(B, S, D)),
            "wqkv": _w((lambda *s: torch.randn(*s, dtype=torch.bfloat16) * 0.8)(D, 3 * D)),
            "wo": _w((lambda *s: torch.randn(*s, dtype=torch.bfloat16) * 0.05)(D, D)),
        }
    _B_in = _B_setup()

    return {
        "A_x": _A_in["x"],
        "A_wqkv": _A_in["wqkv"],
        "A_wo": _A_in["wo"],
        "B_x": _B_in["x"],
        "B_wqkv": _B_in["wqkv"],
        "B_wo": _B_in["wo"],
        "gate_w": _w((lambda *s: torch.randn(*s, dtype=torch.bfloat16) * 0.05)(512) * 16.0),
    }

def reference(A_x, A_wqkv, A_wo, B_x, B_wqkv, B_wo, gate_w):
    def _A_ref(x, wqkv, wo):
        B, S, D = x.shape
        H = 32
        Dh = D // H
        qkv = (lambda x, *d: x.permute(*d))((x @ wqkv).reshape(B, S, 3, H, Dh), 2, 0, 3, 1, 4)
        q, k, v = qkv[0], qkv[1], qkv[2]
        scores = torch.einsum("bhqd,bhkd->bhqk", q, k) * (Dh ** -0.5)
        p = _softmax(scores, axis=-1)
        o = torch.einsum("bhqk,bhkd->bhqd", p, v)
        return (lambda x, *d: x.permute(*d))(o, 0, 2, 1, 3).reshape(B, S, D) @ wo

    def _B_ref(x, wqkv, wo):
        B, S, D = x.shape
        H = 32
        Dh = D // H
        qkv = (lambda x, *d: x.permute(*d))((x @ wqkv).reshape(B, S, 3, H, Dh), 2, 0, 3, 1, 4)
        q, k, v = qkv[0], qkv[1], qkv[2]
        scores = torch.einsum("bhqd,bhkd->bhqk", q, k) * (Dh ** -0.5)
        p = _softmax(scores, axis=-1)
        o = torch.einsum("bhqk,bhkd->bhqd", p, v)
        return (lambda x, *d: x.permute(*d))(o, 0, 2, 1, 3).reshape(B, S, D) @ wo

    x = A_x
    g = _sigmoid((x * gate_w).sum(-1, keepdims=True))
    a = _A_ref(x, A_wqkv, A_wo)
    b = _B_ref(x, B_wqkv, B_wo)
    return g * a + (1 - g) * b
```

```asm
; @launch grid=(256,1,1) block=(512,1,1) lds=163840
.amdgcn_target "amdgcn-amd-amdhsa--gfx950"
.text
.globl gated_mix__mha_block__mha_block__prompt_kernel
.p2align 8
.type gated_mix__mha_block__mha_block__prompt_kernel,@function
gated_mix__mha_block__mha_block__prompt_kernel:
  s_cmp_ge_u32 s2, 256
  s_cbranch_scc1 L_end
  s_load_dwordx4 s[4:7], s[0:1], 0
  s_load_dwordx2 s[8:9], s[0:1], 16
  s_load_dwordx4 s[12:15], s[0:1], 32
  s_load_dwordx4 s[16:19], s[0:1], 48
  s_load_dwordx4 s[20:23], s[0:1], 64
  v_lshrrev_b32 v2, 6, v0
  v_and_b32 v1, 63, v0
  s_and_b32 s24, s2, 7
  s_lshr_b32 s25, s2, 3
  v_readfirstlane_b32 s3, v2
  v_lshlrev_b32 v2, 4, v1
  s_lshr_b32 s40, s24, 1
  s_lshl_b32 s40, s40, 2
  s_and_b32 s41, s25, 3
  s_add_u32 s26, s40, s41
  s_lshr_b32 s28, s26, 3
  s_and_b32 s29, s26, 7
  s_and_b32 s27, s24, 1
  s_lshl_b32 s27, s27, 3
  s_lshr_b32 s41, s25, 2
  s_add_u32 s27, s27, s41
  s_mov_b32 s101, s24
  v_lshrrev_b32 v5, 4, v1
  s_cmp_ge_u32 s3, 4
  s_cbranch_scc0 A_compute
  s_sub_u32 s30, s3, 4
  s_setprio 3
  v_lshrrev_b32 v3, 3, v1
  v_and_b32 v4, 7, v1
  v_xor_b32 v6, v4, v5
  v_lshlrev_b32 v6, 4, v6
  v_lshl_add_u32 v10, v3, 10, v6
  v_add_u32 v7, 4, v5
  v_xor_b32 v7, v4, v7
  v_lshlrev_b32 v7, 4, v7
  v_lshl_add_u32 v11, v3, 10, v7
  v_and_b32 v8, 1, v5
  v_lshlrev_b32 v8, 2, v8
  v_xor_b32 v8, v4, v8
  v_lshlrev_b32 v8, 4, v8
  v_mul_u32_u24 v9, 3072, v3
  v_add_u32 v12, v9, v8
  s_lshl_b32 s54, s30, 15
  s_add_u32 s44, s54, 0
  s_add_u32 s45, s54, 8192
  s_add_u32 s46, s54, 16384
  s_add_u32 s47, s54, 24576
  s_mul_i32 s54, s30, 49152
  s_add_u32 s48, s54, 0
  s_add_u32 s49, s54, 24576
  s_add_u32 s50, s54, 1024
  s_add_u32 s51, s54, 25600
  s_add_u32 s52, s54, 2048
  s_add_u32 s53, s54, 26624
  s_lshl_b32 s55, s30, 12
  s_lshl_b32 s56, s30, 11
  s_add_u32 s56, s56, 16384
  s_lshl_b32 s40, s27, 17
  s_lshl_b32 s41, s29, 7
  s_mov_b32 s62, 131072
  s_mov_b32 s63, 0x20000
  s_sub_u32 s34, 1572864, s41
  s_mov_b32 s35, 0x20000
  s_mov_b32 s57, s101
  s_lshl_b32 s42, s57, 7
  v_add_u32 v10, s42, v10
  v_add_u32 v11, s42, v11
  s_mul_i32 s42, s57, 196608
  v_add_u32 v12, s42, v12
  s_mov_b32 s64, 4294966400
  s_mov_b32 s65, 128
  s_mov_b32 s66, 4293591040
  s_mov_b32 s67, 196608
  s_waitcnt lgkmcnt(0)
  s_cmp_eq_u32 s28, 0
  s_cselect_b32 s32, s6, s12
  s_cselect_b32 s33, s7, s13
  s_add_u32 s60, s4, s40
  s_addc_u32 s61, s5, 0
  s_add_u32 s32, s32, s41
  s_addc_u32 s33, s33, 0
  s_mov_b32 s36, s16
  s_mov_b32 s37, s17
  s_mov_b32 s38, 1024
  s_mov_b32 s39, 0x20000
  s_lshl_b32 s43, s30, 8
  s_add_u32 m0, s43, 122880
  s_add_u32 m0, s56, 0
  s_nop 0
  buffer_load_dwordx4 v12, s[32:35], s48 offen lds
  s_add_u32 m0, s55, 0
  s_add_u32 s57, s57, 1
  buffer_load_dwordx4 v10, s[60:63], s44 offen lds
  s_add_u32 m0, s56, 1024
  s_nop 0
  buffer_load_dwordx4 v12, s[32:35], s49 offen lds
  s_add_u32 m0, s55, 1024
  s_and_b32 s57, s57, 7
  buffer_load_dwordx4 v11, s[60:63], s45 offen lds
  s_add_u32 m0, s56, 8192
  s_cmp_eq_u32 s57, 0
  buffer_load_dwordx4 v12, s[32:35], s50 offen lds
  s_cselect_b32 s42, s64, s65
  s_cselect_b32 s43, s66, s67
  s_add_u32 m0, s55, 2048
  s_nop 0
  buffer_load_dwordx4 v10, s[60:63], s46 offen lds
  s_add_u32 m0, s56, 9216
  s_nop 0
  buffer_load_dwordx4 v12, s[32:35], s51 offen lds
  s_add_u32 m0, s55, 3072
  s_nop 0
  buffer_load_dwordx4 v11, s[60:63], s47 offen lds
  s_add_u32 m0, s56, 16384
  s_nop 0
  buffer_load_dwordx4 v12, s[32:35], s52 offen lds
  s_add_u32 m0, s56, 17408
  s_nop 0
  buffer_load_dwordx4 v12, s[32:35], s53 offen lds
  v_add_u32 v10, s42, v10
  v_add_u32 v11, s42, v11
  v_add_u32 v12, s43, v12
  s_add_u32 s55, s55, 40960
  s_add_u32 s56, s56, 40960
  s_cmp_ge_u32 s56, 122880
  s_cselect_b32 s54, 122880, 0
  s_sub_u32 s55, s55, s54
  s_sub_u32 s56, s56, s54
  s_add_u32 m0, s56, 0
  s_nop 0
  buffer_load_dwordx4 v12, s[32:35], s48 offen lds
  s_add_u32 m0, s55, 0
  s_add_u32 s57, s57, 1
  buffer_load_dwordx4 v10, s[60:63], s44 offen lds
  s_add_u32 m0, s56, 1024
  s_nop 0
  buffer_load_dwordx4 v12, s[32:35], s49 offen lds
  s_add_u32 m0, s55, 1024
  s_and_b32 s57, s57, 7
  buffer_load_dwordx4 v11, s[60:63], s45 offen lds
  s_add_u32 m0, s56, 8192
  s_cmp_eq_u32 s57, 0
  buffer_load_dwordx4 v12, s[32:35], s50 offen lds
  s_cselect_b32 s42, s64, s65
  s_cselect_b32 s43, s66, s67
  s_add_u32 m0, s55, 2048
  s_nop 0
  buffer_load_dwordx4 v10, s[60:63], s46 offen lds
  s_add_u32 m0, s56, 9216
  s_nop 0
  buffer_load_dwordx4 v12, s[32:35], s51 offen lds
  s_add_u32 m0, s55, 3072
  s_nop 0
  buffer_load_dwordx4 v11, s[60:63], s47 offen lds
  s_add_u32 m0, s56, 16384
  s_nop 0
  buffer_load_dwordx4 v12, s[32:35], s52 offen lds
  s_add_u32 m0, s56, 17408
  s_nop 0
  buffer_load_dwordx4 v12, s[32:35], s53 offen lds
  v_add_u32 v10, s42, v10
  v_add_u32 v11, s42, v11
  v_add_u32 v12, s43, v12
  s_add_u32 s55, s55, 40960
  s_add_u32 s56, s56, 40960
  s_cmp_ge_u32 s56, 122880
  s_cselect_b32 s54, 122880, 0
  s_sub_u32 s55, s55, s54
  s_sub_u32 s56, s56, s54
  v_and_b32 v60, 27, v1
  v_cmp_eq_u32 vcc, 16, v60
  v_mov_b32 v61, 0x3f803f80
  s_nop 0
  v_cndmask_b32 v60, 0, v61, vcc
  v_mov_b32 v192, v60
  v_mov_b32 v193, v60
  v_mov_b32 v194, v60
  v_mov_b32 v195, v60
  v_mov_b32 v196, v60
  v_mov_b32 v197, v60
  v_mov_b32 v198, v60
  v_mov_b32 v199, v60
  v_mov_b32 v200, v60
  v_mov_b32 v201, v60
  v_mov_b32 v202, v60
  v_mov_b32 v203, v60
  v_mov_b32 v204, v60
  v_mov_b32 v205, v60
  v_mov_b32 v206, v60
  v_mov_b32 v207, v60
  v_mov_b32 v208, v60
  v_mov_b32 v209, v60
  v_mov_b32 v210, v60
  v_mov_b32 v211, v60
  v_mov_b32 v212, v60
  v_mov_b32 v213, v60
  v_mov_b32 v214, v60
  v_mov_b32 v215, v60
  v_mov_b32 v216, v60
  v_mov_b32 v217, v60
  v_mov_b32 v218, v60
  v_mov_b32 v219, v60
  v_mov_b32 v220, v60
  v_mov_b32 v221, v60
  v_mov_b32 v222, v60
  v_mov_b32 v223, v60
  v_mov_b32 v224, v60
  v_mov_b32 v225, v60
  v_mov_b32 v226, v60
  v_mov_b32 v227, v60
  v_mov_b32 v228, v60
  v_mov_b32 v229, v60
  v_mov_b32 v230, v60
  v_mov_b32 v231, v60
  v_mov_b32 v232, v60
  v_mov_b32 v233, v60
  v_mov_b32 v234, v60
  v_mov_b32 v235, v60
  v_mov_b32 v236, v60
  v_mov_b32 v237, v60
  v_mov_b32 v238, v60
  v_mov_b32 v239, v60
  v_mov_b32 v240, v60
  v_mov_b32 v241, v60
  v_mov_b32 v242, v60
  v_mov_b32 v243, v60
  v_mov_b32 v244, v60
  v_mov_b32 v245, v60
  v_mov_b32 v246, v60
  v_mov_b32 v247, v60
  v_mov_b32 v248, v60
  v_mov_b32 v249, v60
  v_mov_b32 v250, v60
  v_mov_b32 v251, v60
  v_mov_b32 v252, v60
  v_mov_b32 v253, v60
  v_mov_b32 v254, v60
  v_mov_b32 v255, v60
  s_setprio 0
  s_mov_b32 s58, 0
A_ld_loop:
  s_waitcnt vmcnt(10)
  s_barrier
  s_add_u32 m0, s56, 0
  s_nop 0
  buffer_load_dwordx4 v12, s[32:35], s48 offen lds
  s_add_u32 m0, s55, 0
  s_add_u32 s57, s57, 1
  buffer_load_dwordx4 v10, s[60:63], s44 offen lds
  s_add_u32 m0, s56, 1024
  s_nop 0
  buffer_load_dwordx4 v12, s[32:35], s49 offen lds
  s_add_u32 m0, s55, 1024
  s_and_b32 s57, s57, 7
  buffer_load_dwordx4 v11, s[60:63], s45 offen lds
  s_add_u32 m0, s56, 8192
  s_cmp_eq_u32 s57, 0
  buffer_load_dwordx4 v12, s[32:35], s50 offen lds
  s_cselect_b32 s42, s64, s65
  s_cselect_b32 s43, s66, s67
  s_add_u32 m0, s55, 2048
  s_nop 0
  buffer_load_dwordx4 v10, s[60:63], s46 offen lds
  s_add_u32 m0, s56, 9216
  s_nop 0
  buffer_load_dwordx4 v12, s[32:35], s51 offen lds
  s_add_u32 m0, s55, 3072
  s_nop 0
  buffer_load_dwordx4 v11, s[60:63], s47 offen lds
  s_add_u32 m0, s56, 16384
  s_nop 0
  buffer_load_dwordx4 v12, s[32:35], s52 offen lds
  s_add_u32 m0, s56, 17408
  s_nop 0
  buffer_load_dwordx4 v12, s[32:35], s53 offen lds
  v_add_u32 v10, s42, v10
  v_add_u32 v11, s42, v11
  v_add_u32 v12, s43, v12
  s_add_u32 s55, s55, 40960
  s_add_u32 s56, s56, 40960
  s_cmp_ge_u32 s56, 122880
  s_cselect_b32 s54, 122880, 0
  s_sub_u32 s55, s55, s54
  s_sub_u32 s56, s56, s54
  s_add_u32 s58, s58, 1
  s_cmp_lt_u32 s58, 6
  s_cbranch_scc1 A_ld_loop
  s_mov_b32 s36, s16
  s_mov_b32 s37, s17
  s_mov_b32 s38, 1024
  s_mov_b32 s39, 0x20000
  v_and_b32 v13, 15, v1
  v_lshlrev_b32 v13, 4, v13
  v_lshl_add_u32 v14, v5, 10, v13
  s_lshl_b32 s40, s26, 3
  s_and_b32 s41, s30, 1
  s_lshl_b32 s41, s41, 2
  s_add_u32 s29, s40, s41
  s_lshl_b32 s41, s29, 10
  s_cmp_ge_u32 s30, 2
  s_cbranch_scc1 A_nogl
  buffer_load_dwordx4 v[16:19], v14, s[60:63], s41 offen offset:0
  buffer_load_dwordx4 v[20:23], v14, s[60:63], s41 offen offset:256
  buffer_load_dwordx4 v[24:27], v14, s[60:63], s41 offen offset:512
  buffer_load_dwordx4 v[28:31], v14, s[60:63], s41 offen offset:768
  buffer_load_dwordx4 v[32:35], v13, s[36:39], 0 offen offset:0
  buffer_load_dwordx4 v[36:39], v13, s[36:39], 0 offen offset:256
  buffer_load_dwordx4 v[40:43], v13, s[36:39], 0 offen offset:512
  buffer_load_dwordx4 v[44:47], v13, s[36:39], 0 offen offset:768
A_nogl:
  s_waitcnt vmcnt(10)
  s_barrier
  s_waitcnt vmcnt(0)
  s_barrier
  s_setprio 0
  s_mov_b32 s36, s22
  s_mov_b32 s37, s23
  s_mov_b32 s38, 16797696
  s_mov_b32 s39, 0x20000
  s_barrier
  s_cmp_ge_u32 s30, 2
  s_cbranch_scc1 A_join
  v_mov_b32 v48, 0
  s_waitcnt vmcnt(0)
  v_dot2c_f32_bf16 v48, v16, v32
  v_dot2c_f32_bf16 v48, v17, v33
  v_dot2c_f32_bf16 v48, v18, v34
  v_dot2c_f32_bf16 v48, v19, v35
  v_dot2c_f32_bf16 v48, v20, v36
  v_dot2c_f32_bf16 v48, v21, v37
  v_dot2c_f32_bf16 v48, v22, v38
  v_dot2c_f32_bf16 v48, v23, v39
  v_dot2c_f32_bf16 v48, v24, v40
  v_dot2c_f32_bf16 v48, v25, v41
  v_dot2c_f32_bf16 v48, v26, v42
  v_dot2c_f32_bf16 v48, v27, v43
  v_dot2c_f32_bf16 v48, v28, v44
  v_dot2c_f32_bf16 v48, v29, v45
  v_dot2c_f32_bf16 v48, v30, v46
  v_dot2c_f32_bf16 v48, v31, v47
  s_nop 3
  v_add_f32_dpp v48, v48, v48 row_ror:8 row_mask:0xf bank_mask:0xf
  s_nop 1
  v_add_f32_dpp v48, v48, v48 row_ror:4 row_mask:0xf bank_mask:0xf
  s_nop 1
  v_add_f32_dpp v48, v48, v48 row_ror:2 row_mask:0xf bank_mask:0xf
  s_nop 1
  v_add_f32_dpp v48, v48, v48 row_ror:1 row_mask:0xf bank_mask:0xf
  s_nop 1
  v_mul_f32 v48, 0xbfb8aa3b, v48
  v_exp_f32 v48, v48
  s_nop 0
  v_add_f32 v48, 1.0, v48
  v_rcp_f32 v48, v48
  s_lshl_b32 s41, s27, 7
  s_add_u32 s41, s41, s29
  s_lshl_b32 s41, s41, 2
  s_add_u32 s41, s41, 16789504
  v_lshlrev_b32 v49, 2, v5
  v_and_b32 v50, 15, v1
  v_cmp_eq_u32 vcc, 0, v50
  s_and_saveexec_b64 s[58:59], vcc
  buffer_store_dword v48, v49, s[36:39], s41 offen sc1
  s_mov_b64 exec, s[58:59]
  s_branch A_join
A_compute:
  s_and_b32 s30, s3, 1
  s_lshr_b32 s31, s3, 1
  v_and_b32 v20, 31, v1
  v_lshrrev_b32 v21, 5, v1
  v_lshrrev_b32 v22, 1, v1
  v_and_b32 v22, 7, v22
  s_lshl_b32 s40, s30, 13
  v_lshlrev_b32 v23, 7, v20
  v_add_u32 v23, s40, v23
  v_add_u32 v24, 0, v21
  v_xor_b32 v24, v24, v22
  v_lshl_add_u32 v16, v24, 4, v23
  v_add_u32 v24, 2, v21
  v_xor_b32 v24, v24, v22
  v_lshl_add_u32 v17, v24, 4, v23
  v_add_u32 v24, 4, v21
  v_xor_b32 v24, v24, v22
  v_lshl_add_u32 v18, v24, 4, v23
  v_add_u32 v24, 6, v21
  v_xor_b32 v24, v24, v22
  v_lshl_add_u32 v19, v24, 4, v23
  v_and_b32 v26, 15, v1
  v_lshrrev_b32 v27, 2, v26
  v_lshl_add_u32 v28, v21, 3, v27
  v_lshlrev_b32 v28, 7, v28
  v_and_b32 v29, 1, v5
  v_lshlrev_b32 v29, 1, v29
  v_bfe_u32 v30, v26, 1, 1
  v_add_u32 v29, v29, v30
  s_lshl_b32 s40, s31, 2
  v_add_u32 v29, s40, v29
  v_bfe_u32 v30, v27, 1, 1
  v_lshlrev_b32 v30, 2, v30
  v_xor_b32 v29, v29, v30
  v_lshl_add_u32 v28, v29, 4, v28
  v_and_b32 v30, 1, v26
  v_lshl_add_u32 v25, v30, 3, v28
  v_and_b32 v190, 27, v1
  v_cmp_eq_u32 vcc, 16, v190
  v_mov_b32 v191, 0x3f803f80
  s_nop 0
  v_cndmask_b32 v190, 0, v191, vcc
  v_mov_b32 v192, v190
  v_mov_b32 v193, v190
  v_mov_b32 v194, v190
  v_mov_b32 v195, v190
  v_mov_b32 v196, v190
  v_mov_b32 v197, v190
  v_mov_b32 v198, v190
  v_mov_b32 v199, v190
  v_mov_b32 v200, v190
  v_mov_b32 v201, v190
  v_mov_b32 v202, v190
  v_mov_b32 v203, v190
  v_mov_b32 v204, v190
  v_mov_b32 v205, v190
  v_mov_b32 v206, v190
  v_mov_b32 v207, v190
  v_mov_b32 v208, v190
  v_mov_b32 v209, v190
  v_mov_b32 v210, v190
  v_mov_b32 v211, v190
  v_mov_b32 v212, v190
  v_mov_b32 v213, v190
  v_mov_b32 v214, v190
  v_mov_b32 v215, v190
  v_mov_b32 v216, v190
  v_mov_b32 v217, v190
  v_mov_b32 v218, v190
  v_mov_b32 v219, v190
  v_mov_b32 v220, v190
  v_mov_b32 v221, v190
  v_mov_b32 v222, v190
  v_mov_b32 v223, v190
  v_mov_b32 v224, v190
  v_mov_b32 v225, v190
  v_mov_b32 v226, v190
  v_mov_b32 v227, v190
  v_mov_b32 v228, v190
  v_mov_b32 v229, v190
  v_mov_b32 v230, v190
  v_mov_b32 v231, v190
  v_mov_b32 v232, v190
  v_mov_b32 v233, v190
  v_mov_b32 v234, v190
  v_mov_b32 v235, v190
  v_mov_b32 v236, v190
  v_mov_b32 v237, v190
  v_mov_b32 v238, v190
  v_mov_b32 v239, v190
  v_mov_b32 v240, v190
  v_mov_b32 v241, v190
  v_mov_b32 v242, v190
  v_mov_b32 v243, v190
  v_mov_b32 v244, v190
  v_mov_b32 v245, v190
  v_mov_b32 v246, v190
  v_mov_b32 v247, v190
  v_mov_b32 v248, v190
  v_mov_b32 v249, v190
  v_mov_b32 v250, v190
  v_mov_b32 v251, v190
  v_mov_b32 v252, v190
  v_mov_b32 v253, v190
  v_mov_b32 v254, v190
  v_mov_b32 v255, v190
  v_mov_b64 v[64:65], 0
  v_mov_b64 v[66:67], 0
  v_mov_b64 v[68:69], 0
  v_mov_b64 v[70:71], 0
  v_mov_b64 v[72:73], 0
  v_mov_b64 v[74:75], 0
  v_mov_b64 v[76:77], 0
  v_mov_b64 v[78:79], 0
  v_mov_b64 v[80:81], 0
  v_mov_b64 v[82:83], 0
  v_mov_b64 v[84:85], 0
  v_mov_b64 v[86:87], 0
  v_mov_b64 v[88:89], 0
  v_mov_b64 v[90:91], 0
  v_mov_b64 v[92:93], 0
  v_mov_b64 v[94:95], 0
  v_mov_b64 v[96:97], 0
  v_mov_b64 v[98:99], 0
  v_mov_b64 v[100:101], 0
  v_mov_b64 v[102:103], 0
  v_mov_b64 v[104:105], 0
  v_mov_b64 v[106:107], 0
  v_mov_b64 v[108:109], 0
  v_mov_b64 v[110:111], 0
  v_mov_b64 v[112:113], 0
  v_mov_b64 v[114:115], 0
  v_mov_b64 v[116:117], 0
  v_mov_b64 v[118:119], 0
  v_mov_b64 v[120:121], 0
  v_mov_b64 v[122:123], 0
  v_mov_b64 v[124:125], 0
  v_mov_b64 v[126:127], 0
  v_mov_b64 v[128:129], 0
  v_mov_b64 v[130:131], 0
  v_mov_b64 v[132:133], 0
  v_mov_b64 v[134:135], 0
  v_mov_b64 v[136:137], 0
  v_mov_b64 v[138:139], 0
  v_mov_b64 v[140:141], 0
  v_mov_b64 v[142:143], 0
  v_mov_b64 v[144:145], 0
  v_mov_b64 v[146:147], 0
  v_mov_b64 v[148:149], 0
  v_mov_b64 v[150:151], 0
  v_mov_b64 v[152:153], 0
  v_mov_b64 v[154:155], 0
  v_mov_b64 v[156:157], 0
  v_mov_b64 v[158:159], 0
  s_lshl_b32 s40, s26, 2
  s_lshl_b32 s41, s31, 1
  s_add_u32 s40, s40, s41
  s_lshl_b32 s40, s40, 6
  s_lshl_b32 s41, s27, 2
  s_add_u32 s40, s40, s41
  s_lshl_b32 s41, s30, 1
  s_add_u32 s40, s40, s41
  s_lshl_b32 s46, s40, 11
  s_add_u32 s46, s46, 4194304
  s_mov_b32 s48, 0x3eb8aa3b
  v_and_b32 v11, 15, v1
  v_lshlrev_b32 v11, 4, v11
  v_lshl_add_u32 v11, v21, 9, v11
  v_bfe_u32 v12, v1, 4, 1
  v_lshl_add_u32 v13, v12, 13, v11
  v_lshl_add_u32 v11, v12, 17, v11
  v_add_u32 v11, 1024, v11
  s_add_u32 s47, s46, 131072
  s_mov_b32 s38, 16797696
  s_mov_b32 s39, 0x20000
  s_mov_b32 s57, 0
  s_mov_b32 s58, 0
  v_add_u32 v20, s57, v16
  v_add_u32 v21, s57, v17
  v_add_u32 v22, s57, v18
  v_add_u32 v23, s57, v19
  v_add_u32 v24, s57, v25
  s_waitcnt lgkmcnt(0)
  s_mov_b32 s36, s22
  s_mov_b32 s37, s23
  s_lshl_b32 s40, s2, 2
  s_add_u32 s40, s40, s3
  s_and_b32 s41, s40, 511
  s_mul_i32 s41, s41, 3072
  s_cmp_lt_u32 s40, 512
  s_cselect_b32 s42, s6, s12
  s_cselect_b32 s43, s7, s13
  s_add_u32 s42, s42, s41
  s_addc_u32 s43, s43, 0
  global_load_dwordx4 v[180:183], v2, s[42:43]
  global_load_dwordx4 v[180:183], v2, s[42:43] offset:1024
  global_load_dwordx4 v[180:183], v2, s[42:43] offset:2048
  s_lshl_b32 s40, s2, 3
  s_lshl_b32 s41, s3, 1
  s_add_u32 s40, s40, s41
  s_lshl_b32 s40, s40, 10
  s_add_u32 s42, s4, s40
  s_addc_u32 s43, s5, 0
  global_load_dwordx4 v[180:183], v2, s[42:43]
  global_load_dwordx4 v[180:183], v2, s[42:43] offset:1024
  s_cmp_lg_u32 s3, 3
  s_cbranch_scc1 A_nocpf
  s_cmp_ge_u32 s25, (L_codeend-gated_mix__mha_block__mha_block__prompt_kernel)>>10
  s_cbranch_scc1 A_nocpf
  s_getpc_b64 s[42:43]
A_pc:
  s_sub_u32 s42, s42, A_pc-gated_mix__mha_block__mha_block__prompt_kernel
  s_subb_u32 s43, s43, 0
  s_lshl_b32 s40, s25, 10
  s_add_u32 s42, s42, s40
  s_addc_u32 s43, s43, 0
  global_load_dwordx4 v[180:183], v2, s[42:43]
A_nocpf:
  s_cmp_lg_u32 s3, 0
  s_cbranch_scc1 A_nononce
  s_memrealtime s[40:41]
  s_waitcnt lgkmcnt(0)
  s_or_b32 s40, s40, 1
  v_mov_b32 v186, s40
  v_mov_b32 v187, 0
  v_mov_b32 v188, 0
  s_mov_b64 exec, 1
  global_atomic_cmpswap v189, v188, v[186:187], s[20:21] sc0
  s_mov_b64 exec, -1
A_nononce:
  s_barrier
  ds_read_b64_tr_b16 v[40:41], v24 offset:16384
  ds_read_b64_tr_b16 v[42:43], v24 offset:16896
  ds_read_b128 v[32:35], v20 offset:0
  ds_read_b128 v[36:39], v20 offset:4096
  ds_read_b64_tr_b16 v[44:45], v24 offset:24576
  ds_read_b64_tr_b16 v[46:47], v24 offset:25088
  ds_read_b64_tr_b16 v[48:49], v24 offset:32768
  ds_read_b64_tr_b16 v[50:51], v24 offset:33280
A_loop:
  s_waitcnt lgkmcnt(5)
  v_mfma_f32_32x32x16_bf16 v[64:79], v[40:43], v[32:35], v[64:79]
  ds_read_b64_tr_b16 v[168:169], v24 offset:18432
  ds_read_b64_tr_b16 v[170:171], v24 offset:18944
  s_waitcnt lgkmcnt(6)
  v_mfma_f32_32x32x16_bf16 v[112:127], v[40:43], v[36:39], v[112:127]
  ds_read_b128 v[160:163], v21 offset:0
  ds_read_b128 v[164:167], v21 offset:4096
  s_waitcnt lgkmcnt(6)
  v_mfma_f32_32x32x16_bf16 v[80:95], v[44:47], v[32:35], v[80:95]
  ds_read_b64_tr_b16 v[172:173], v24 offset:26624
  ds_read_b64_tr_b16 v[174:175], v24 offset:27136
  v_mfma_f32_32x32x16_bf16 v[128:143], v[44:47], v[36:39], v[128:143]
  ds_read_b64_tr_b16 v[176:177], v24 offset:34816
  ds_read_b64_tr_b16 v[178:179], v24 offset:35328
  s_waitcnt lgkmcnt(8)
  v_mfma_f32_32x32x16_bf16 v[96:111], v[32:35], v[48:51], v[96:111]
  v_mfma_f32_32x32x16_bf16 v[144:159], v[36:39], v[48:51], v[144:159]
  s_waitcnt lgkmcnt(5)
  v_mfma_f32_32x32x16_bf16 v[64:79], v[168:171], v[160:163], v[64:79]
  ds_read_b64_tr_b16 v[40:41], v24 offset:20480
  ds_read_b64_tr_b16 v[42:43], v24 offset:20992
  s_waitcnt lgkmcnt(6)
  v_mfma_f32_32x32x16_bf16 v[112:127], v[168:171], v[164:167], v[112:127]
  ds_read_b128 v[32:35], v22 offset:0
  ds_read_b128 v[36:39], v22 offset:4096
  s_waitcnt lgkmcnt(6)
  v_mfma_f32_32x32x16_bf16 v[80:95], v[172:175], v[160:163], v[80:95]
  ds_read_b64_tr_b16 v[44:45], v24 offset:28672
  ds_read_b64_tr_b16 v[46:47], v24 offset:29184
  v_mfma_f32_32x32x16_bf16 v[128:143], v[172:175], v[164:167], v[128:143]
  ds_read_b64_tr_b16 v[48:49], v24 offset:36864
  ds_read_b64_tr_b16 v[50:51], v24 offset:37376
  s_waitcnt lgkmcnt(8)
  v_mfma_f32_32x32x16_bf16 v[96:111], v[160:163], v[176:179], v[96:111]
  v_mfma_f32_32x32x16_bf16 v[144:159], v[164:167], v[176:179], v[144:159]
  s_waitcnt lgkmcnt(5)
  v_mfma_f32_32x32x16_bf16 v[64:79], v[40:43], v[32:35], v[64:79]
  ds_read_b64_tr_b16 v[168:169], v24 offset:22528
  ds_read_b64_tr_b16 v[170:171], v24 offset:23040
  s_waitcnt lgkmcnt(6)
  v_mfma_f32_32x32x16_bf16 v[112:127], v[40:43], v[36:39], v[112:127]
  ds_read_b128 v[160:163], v23 offset:0
  ds_read_b128 v[164:167], v23 offset:4096
  s_waitcnt lgkmcnt(6)
  v_mfma_f32_32x32x16_bf16 v[80:95], v[44:47], v[32:35], v[80:95]
  ds_read_b64_tr_b16 v[172:173], v24 offset:30720
  ds_read_b64_tr_b16 v[174:175], v24 offset:31232
  v_mfma_f32_32x32x16_bf16 v[128:143], v[44:47], v[36:39], v[128:143]
  ds_read_b64_tr_b16 v[176:177], v24 offset:38912
  ds_read_b64_tr_b16 v[178:179], v24 offset:39424
  s_waitcnt lgkmcnt(8)
  v_mfma_f32_32x32x16_bf16 v[96:111], v[32:35], v[48:51], v[96:111]
  v_mfma_f32_32x32x16_bf16 v[144:159], v[36:39], v[48:51], v[144:159]
  s_cmp_eq_u32 s58, 7
  s_cbranch_scc1 A_last
  s_add_u32 s57, s57, 40960
  s_cmp_ge_u32 s57, 122880
  s_cselect_b32 s40, 122880, 0
  s_sub_u32 s57, s57, s40
  v_add_u32 v20, s57, v16
  v_add_u32 v21, s57, v17
  v_add_u32 v22, s57, v18
  v_add_u32 v23, s57, v19
  v_add_u32 v24, s57, v25
  s_waitcnt lgkmcnt(5)
  v_mfma_f32_32x32x16_bf16 v[64:79], v[168:171], v[160:163], v[64:79]
  s_waitcnt lgkmcnt(0)
  s_barrier
  ds_read_b64_tr_b16 v[40:41], v24 offset:16384
  ds_read_b64_tr_b16 v[42:43], v24 offset:16896
  s_waitcnt lgkmcnt(6)
  v_mfma_f32_32x32x16_bf16 v[112:127], v[168:171], v[164:167], v[112:127]
  ds_read_b128 v[32:35], v20 offset:0
  ds_read_b128 v[36:39], v20 offset:4096
  s_waitcnt lgkmcnt(6)
  v_mfma_f32_32x32x16_bf16 v[80:95], v[172:175], v[160:163], v[80:95]
  ds_read_b64_tr_b16 v[44:45], v24 offset:24576
  ds_read_b64_tr_b16 v[46:47], v24 offset:25088
  v_mfma_f32_32x32x16_bf16 v[128:143], v[172:175], v[164:167], v[128:143]
  ds_read_b64_tr_b16 v[48:49], v24 offset:32768
  ds_read_b64_tr_b16 v[50:51], v24 offset:33280
  s_waitcnt lgkmcnt(8)
  v_mfma_f32_32x32x16_bf16 v[96:111], v[160:163], v[176:179], v[96:111]
  v_mfma_f32_32x32x16_bf16 v[144:159], v[164:167], v[176:179], v[144:159]
  s_add_u32 s58, s58, 1
  s_branch A_loop
A_last:
  s_waitcnt lgkmcnt(5)
  v_mfma_f32_32x32x16_bf16 v[64:79], v[168:171], v[160:163], v[64:79]
  s_waitcnt lgkmcnt(4)
  v_mfma_f32_32x32x16_bf16 v[112:127], v[168:171], v[164:167], v[112:127]
  s_waitcnt lgkmcnt(2)
  v_mfma_f32_32x32x16_bf16 v[80:95], v[172:175], v[160:163], v[80:95]
  v_mfma_f32_32x32x16_bf16 v[128:143], v[172:175], v[164:167], v[128:143]
  s_waitcnt lgkmcnt(0)
  v_mfma_f32_32x32x16_bf16 v[96:111], v[160:163], v[176:179], v[96:111]
  v_mfma_f32_32x32x16_bf16 v[144:159], v[164:167], v[176:179], v[144:159]
  s_barrier
  s_lshl_b32 s40, s31, 3
  s_lshl_b32 s41, s30, 1
  s_add_u32 s40, s40, s41
  s_lshl_b32 s41, s40, 10
  v_add_u32 v16, s41, v2
  s_lshl_b32 s41, s40, 11
  v_add_u32 v17, s41, v2
  v_add_u32 v18, s41, v13
  s_nop 3
  s_cmp_lg_u32 s3, 0
  s_cbranch_scc1 A_nononce2
  s_waitcnt vmcnt(0)
  v_cmp_eq_u32 vcc, 0, v189
  s_nop 1
  v_cndmask_b32 v186, v189, v186, vcc
  v_mov_b32 v188, 160000
  s_mov_b64 exec, 1
  ds_write_b64 v188, v[186:187]
  ds_write_b32 v188, v187 offset:8
  s_mov_b64 exec, -1
A_nononce2:
  v_cvt_pk_bf16_f32 v80, v80, v81
  v_cvt_pk_bf16_f32 v81, v82, v83
  v_cvt_pk_bf16_f32 v82, v84, v85
  v_cvt_pk_bf16_f32 v83, v86, v87
  v_cvt_pk_bf16_f32 v84, v88, v89
  v_cvt_pk_bf16_f32 v85, v90, v91
  v_cvt_pk_bf16_f32 v86, v92, v93
  v_cvt_pk_bf16_f32 v87, v94, v95
  buffer_store_dwordx4 v[80:83], v2, s[36:39], s46 offen offset:0 sc1
  buffer_store_dwordx4 v[84:87], v2, s[36:39], s47 offen offset:0 sc1
  ds_write_b128 v17, v[80:83] offset:16384
  ds_write_b128 v17, v[84:87] offset:24576
  v_cvt_pk_bf16_f32 v96, v96, v97
  v_cvt_pk_bf16_f32 v97, v98, v99
  v_cvt_pk_bf16_f32 v98, v100, v101
  v_cvt_pk_bf16_f32 v99, v102, v103
  v_cvt_pk_bf16_f32 v100, v104, v105
  v_cvt_pk_bf16_f32 v101, v106, v107
  v_cvt_pk_bf16_f32 v102, v108, v109
  v_cvt_pk_bf16_f32 v103, v110, v111
  buffer_store_dwordx4 v[96:99], v11, s[36:39], s46 offen offset:0 sc1
  buffer_store_dwordx4 v[100:103], v11, s[36:39], s46 offen offset:256 sc1
  ds_write_b128 v18, v[96:99] offset:17408
  ds_write_b128 v18, v[100:103] offset:17664
  v_cvt_pk_bf16_f32 v128, v128, v129
  v_cvt_pk_bf16_f32 v129, v130, v131
  v_cvt_pk_bf16_f32 v130, v132, v133
  v_cvt_pk_bf16_f32 v131, v134, v135
  v_cvt_pk_bf16_f32 v132, v136, v137
  v_cvt_pk_bf16_f32 v133, v138, v139
  v_cvt_pk_bf16_f32 v134, v140, v141
  v_cvt_pk_bf16_f32 v135, v142, v143
  buffer_store_dwordx4 v[128:131], v2, s[36:39], s46 offen offset:2048 sc1
  buffer_store_dwordx4 v[132:135], v2, s[36:39], s47 offen offset:2048 sc1
  ds_write_b128 v17, v[128:131] offset:18432
  ds_write_b128 v17, v[132:135] offset:26624
  v_cvt_pk_bf16_f32 v144, v144, v145
  v_cvt_pk_bf16_f32 v145, v146, v147
  v_cvt_pk_bf16_f32 v146, v148, v149
  v_cvt_pk_bf16_f32 v147, v150, v151
  v_cvt_pk_bf16_f32 v148, v152, v153
  v_cvt_pk_bf16_f32 v149, v154, v155
  v_cvt_pk_bf16_f32 v150, v156, v157
  v_cvt_pk_bf16_f32 v151, v158, v159
  buffer_store_dwordx4 v[144:147], v11, s[36:39], s46 offen offset:2048 sc1
  buffer_store_dwordx4 v[148:151], v11, s[36:39], s46 offen offset:2304 sc1
  ds_write_b128 v18, v[144:147] offset:19456
  ds_write_b128 v18, v[148:151] offset:19712
  v_mul_f32 v64, s48, v64
  v_mul_f32 v65, s48, v65
  v_mul_f32 v66, s48, v66
  v_mul_f32 v67, s48, v67
  v_mul_f32 v68, s48, v68
  v_mul_f32 v69, s48, v69
  v_mul_f32 v70, s48, v70
  v_mul_f32 v71, s48, v71
  v_mul_f32 v72, s48, v72
  v_mul_f32 v73, s48, v73
  v_mul_f32 v74, s48, v74
  v_mul_f32 v75, s48, v75
  v_mul_f32 v76, s48, v76
  v_mul_f32 v77, s48, v77
  v_mul_f32 v78, s48, v78
  v_mul_f32 v79, s48, v79
  v_cvt_pk_bf16_f32 v64, v64, v65
  v_cvt_pk_bf16_f32 v65, v66, v67
  v_cvt_pk_bf16_f32 v66, v68, v69
  v_cvt_pk_bf16_f32 v67, v70, v71
  v_cvt_pk_bf16_f32 v68, v72, v73
  v_cvt_pk_bf16_f32 v69, v74, v75
  v_cvt_pk_bf16_f32 v70, v76, v77
  v_cvt_pk_bf16_f32 v71, v78, v79
  ds_write_b128 v16, v[64:67] offset:0
  ds_write_b128 v16, v[68:71] offset:4096
  v_mul_f32 v112, s48, v112
  v_mul_f32 v113, s48, v113
  v_mul_f32 v114, s48, v114
  v_mul_f32 v115, s48, v115
  v_mul_f32 v116, s48, v116
  v_mul_f32 v117, s48, v117
  v_mul_f32 v118, s48, v118
  v_mul_f32 v119, s48, v119
  v_mul_f32 v120, s48, v120
  v_mul_f32 v121, s48, v121
  v_mul_f32 v122, s48, v122
  v_mul_f32 v123, s48, v123
  v_mul_f32 v124, s48, v124
  v_mul_f32 v125, s48, v125
  v_mul_f32 v126, s48, v126
  v_mul_f32 v127, s48, v127
  v_cvt_pk_bf16_f32 v112, v112, v113
  v_cvt_pk_bf16_f32 v113, v114, v115
  v_cvt_pk_bf16_f32 v114, v116, v117
  v_cvt_pk_bf16_f32 v115, v118, v119
  v_cvt_pk_bf16_f32 v116, v120, v121
  v_cvt_pk_bf16_f32 v117, v122, v123
  v_cvt_pk_bf16_f32 v118, v124, v125
  v_cvt_pk_bf16_f32 v119, v126, v127
  ds_write_b128 v16, v[112:115] offset:1024
  ds_write_b128 v16, v[116:119] offset:5120
A_join:
  s_waitcnt lgkmcnt(0)
  s_barrier
  s_lshr_b32 s30, s3, 1
  s_and_b32 s31, s3, 1
  s_lshl_b32 s32, s26, 2
  s_add_u32 s32, s32, s30
  s_lshl_b32 s33, s27, 2
  s_lshl_b32 s40, s31, 1
  s_add_u32 s33, s33, s40
  s_lshl_b32 s46, s32, 17
  s_add_u32 s46, s46, 4194304
  s_lshl_b32 s40, s30, 12
  s_lshl_b32 s41, s31, 11
  s_add_u32 s40, s40, s41
  v_add_u32 v158, s40, v2
  ds_read_b128 v[4:7], v158 offset:0
  ds_read_b128 v[8:11], v158 offset:1024
  v_and_b32 v159, 31, v1
  v_lshlrev_b32 v159, 2, v159
  s_lshl_b32 s41, s31, 8
  v_add_u32 v159, s41, v159
  s_mov_b32 s52, 0x0000ffff
  s_mov_b32 s53, 0x0000ffff
  s_lshl_b32 s40, s30, 13
  v_add_u32 v158, s40, v2
  ds_read_b128 v[108:111], v158 offset:16384
  ds_read_b128 v[112:115], v158 offset:18432
  ds_read_b128 v[116:119], v158 offset:20480
  ds_read_b128 v[120:123], v158 offset:22528
  s_mov_b64 exec, s[52:53]
  ds_read_b128 v[192:195], v158 offset:17408
  ds_read_b128 v[196:199], v158 offset:17664
  ds_read_b128 v[200:203], v158 offset:19456
  ds_read_b128 v[204:207], v158 offset:19712
  ds_read_b128 v[208:211], v158 offset:21504
  ds_read_b128 v[212:215], v158 offset:21760
  ds_read_b128 v[216:219], v158 offset:23552
  ds_read_b128 v[220:223], v158 offset:23808
  s_mov_b64 exec, -1
  v_mov_b32 v160, 160000
  ds_read_b32 v161, v160
  s_waitcnt lgkmcnt(0)
  v_readfirstlane_b32 s68, v161
  v_lshrrev_b32 v162, 3, v1
  v_and_b32 v163, 7, v1
  v_bfe_u32 v164, v1, 4, 1
  v_lshlrev_b32 v164, 2, v164
  v_xor_b32 v164, v163, v164
  v_lshlrev_b32 v164, 4, v164
  v_lshl_add_u32 v162, v162, 10, v164
  s_cmp_lt_u32 s3, 4
  s_cselect_b32 s60, s8, s14
  s_cselect_b32 s61, s9, s15
  s_and_b32 s56, s3, 3
  s_lshl_b32 s56, s56, 17
  s_and_b32 s57, s26, 7
  s_lshl_b32 s57, s57, 7
  s_add_u32 s56, s56, s57
  s_add_u32 s60, s60, s56
  s_addc_u32 s61, s61, 0
  s_sub_u32 s62, 524288, s56
  s_mov_b32 s63, 0x20000
  s_lshl_b32 s58, s3, 14
  s_mov_b32 s59, 0
  s_mov_b32 s49, 0
  s_mov_b32 s50, 0
  s_mov_b32 s54, 0
  s_lshl_b32 s45, 1, s27
  s_setprio 3
  v_mfma_f32_32x32x16_bf16 v[12:27], v[108:111], v[4:7], 0
  v_mfma_f32_32x32x16_bf16 v[28:43], v[108:111], v[8:11], 0
  s_nop 7
  s_nop 7
  v_max3_f32 v158, v12, v13, v14
  v_max3_f32 v158, v158, v15, v16
  v_max3_f32 v158, v158, v17, v18
  v_max3_f32 v158, v158, v19, v20
  v_max3_f32 v158, v158, v21, v22
  v_max3_f32 v158, v158, v23, v24
  v_max3_f32 v158, v158, v25, v26
  v_max_f32 v158, v158, v27
  v_max3_f32 v159, v28, v29, v30
  v_max3_f32 v159, v159, v31, v32
  v_max3_f32 v159, v159, v33, v34
  v_max3_f32 v159, v159, v35, v36
  v_max3_f32 v159, v159, v37, v38
  v_max3_f32 v159, v159, v39, v40
  v_max3_f32 v159, v159, v41, v42
  v_max_f32 v159, v159, v43
B_setmax:
  v_mov_b32 v160, v158
  s_nop 1
  v_permlane32_swap_b32 v158, v160
  s_nop 1
  v_max_f32 v158, v158, v160
  v_sub_f32 v76, 0, v158
  v_sub_f32 v77, 0, v158
  v_mov_b64 v[44:45], 0
  v_mov_b64 v[46:47], 0
  v_mov_b64 v[48:49], 0
  v_mov_b64 v[50:51], 0
  v_mov_b64 v[52:53], 0
  v_mov_b64 v[54:55], 0
  v_mov_b64 v[56:57], 0
  v_mov_b64 v[58:59], 0
  v_mov_b64 v[78:79], v[76:77]
  v_mov_b64 v[80:81], v[76:77]
  v_mov_b64 v[82:83], v[76:77]
  v_mov_b64 v[84:85], v[76:77]
  v_mov_b64 v[86:87], v[76:77]
  v_mov_b64 v[88:89], v[76:77]
  v_mov_b64 v[90:91], v[76:77]
  v_mov_b32 v160, v159
  s_nop 1
  v_permlane32_swap_b32 v159, v160
  s_nop 1
  v_max_f32 v159, v159, v160
  v_sub_f32 v92, 0, v159
  v_sub_f32 v93, 0, v159
  v_mov_b64 v[60:61], 0
  v_mov_b64 v[62:63], 0
  v_mov_b64 v[64:65], 0
  v_mov_b64 v[66:67], 0
  v_mov_b64 v[68:69], 0
  v_mov_b64 v[70:71], 0
  v_mov_b64 v[72:73], 0
  v_mov_b64 v[74:75], 0
  v_mov_b64 v[94:95], v[92:93]
  v_mov_b64 v[96:97], v[92:93]
  v_mov_b64 v[98:99], v[92:93]
  v_mov_b64 v[100:101], v[92:93]
  v_mov_b64 v[102:103], v[92:93]
  v_mov_b64 v[104:105], v[92:93]
  v_mov_b64 v[106:107], v[92:93]
  v_mfma_f32_32x32x16_bf16 v[12:27], v[108:111], v[4:7], v[76:91]
  v_mov_b32 v152, 0
  v_mov_b32 v153, 0
  v_mov_b32 v154, 0
  v_mov_b32 v155, 0
  s_mov_b32 s44, s27
  s_mov_b32 s55, 0
  s_nop 7
B_loop:
  v_exp_f32 v12, v12
  v_exp_f32 v13, v13
  v_mfma_f32_32x32x16_bf16 v[60:75], v[252:255], v[152:155], v[60:75]
  v_exp_f32 v14, v14
  v_exp_f32 v15, v15
  v_exp_f32 v16, v16
  v_exp_f32 v17, v17
  v_exp_f32 v18, v18
  v_exp_f32 v19, v19
  v_mfma_f32_32x32x16_bf16 v[28:43], v[108:111], v[8:11], v[92:107]
  s_cmp_lt_u32 s49, 2
  s_cbranch_scc1 B_late0
  s_add_u32 s44, s44, 1
  s_and_b32 s44, s44, 15
  s_bitcmp1_b32 s45, s44
  s_cbranch_scc0 B_poll0
B_pf0:
  s_lshl_b32 s47, s44, 13
  s_add_u32 s47, s47, s46
  s_add_u32 s48, s47, 4096
  buffer_load_dwordx4 v[124:127], v2, s[36:39], s47 offen offset:0 sc1
B_late0_ret:
  v_cvt_pk_bf16_f32 v140, v12, v13
  v_cvt_pk_bf16_f32 v141, v14, v15
  v_cvt_pk_bf16_f32 v142, v16, v17
  v_cvt_pk_bf16_f32 v143, v18, v19
  v_exp_f32 v20, v20
  v_exp_f32 v21, v21
  v_exp_f32 v22, v22
  v_exp_f32 v23, v23
  s_waitcnt vmcnt(9)
  v_mfma_f32_32x32x16_bf16 v[44:59], v[192:195], v[140:143], v[44:59]
  v_exp_f32 v24, v24
  v_exp_f32 v25, v25
  v_exp_f32 v26, v26
  v_exp_f32 v27, v27
  v_exp_f32 v28, v28
  v_exp_f32 v29, v29
  v_cvt_pk_bf16_f32 v144, v20, v21
  v_cvt_pk_bf16_f32 v145, v22, v23
  v_cvt_pk_bf16_f32 v146, v24, v25
  v_cvt_pk_bf16_f32 v147, v26, v27
  v_exp_f32 v30, v30
  v_exp_f32 v31, v31
  v_mfma_f32_32x32x16_bf16 v[44:59], v[196:199], v[144:147], v[44:59]
  v_exp_f32 v32, v32
  v_exp_f32 v33, v33
  v_exp_f32 v34, v34
  v_exp_f32 v35, v35
  v_mfma_f32_32x32x16_bf16 v[12:27], v[112:115], v[4:7], v[76:91]
  v_exp_f32 v36, v36
  v_exp_f32 v37, v37
  v_cvt_pk_bf16_f32 v148, v28, v29
  v_cvt_pk_bf16_f32 v149, v30, v31
  v_cvt_pk_bf16_f32 v150, v32, v33
  v_cvt_pk_bf16_f32 v151, v34, v35
  v_exp_f32 v38, v38
  v_exp_f32 v39, v39
  v_mfma_f32_32x32x16_bf16 v[60:75], v[192:195], v[148:151], v[60:75]
  s_cmp_lt_u32 s49, 2
  s_cbranch_scc1 B_gv0
  s_mov_b64 exec, s[52:53]
  buffer_load_dwordx4 v[224:227], v2, s[36:39], s47 offen offset:1024 sc1
  buffer_load_dwordx4 v[228:231], v2, s[36:39], s47 offen offset:1280 sc1
  s_mov_b64 exec, -1
B_gv0:
  v_exp_f32 v40, v40
  v_exp_f32 v41, v41
  v_exp_f32 v42, v42
  v_exp_f32 v43, v43
  v_cvt_pk_bf16_f32 v152, v36, v37
  v_cvt_pk_bf16_f32 v153, v38, v39
  v_cvt_pk_bf16_f32 v154, v40, v41
  v_cvt_pk_bf16_f32 v155, v42, v43
  v_exp_f32 v12, v12
  v_exp_f32 v13, v13
  v_mfma_f32_32x32x16_bf16 v[60:75], v[196:199], v[152:155], v[60:75]
  v_exp_f32 v14, v14
  v_exp_f32 v15, v15
  v_exp_f32 v16, v16
  v_exp_f32 v17, v17
  v_exp_f32 v18, v18
  v_exp_f32 v19, v19
  v_mfma_f32_32x32x16_bf16 v[28:43], v[112:115], v[8:11], v[92:107]
  s_cmp_lt_u32 s49, 2
  s_cbranch_scc1 B_late1
  buffer_load_dwordx4 v[128:131], v2, s[36:39], s47 offen offset:2048 sc1
B_late1_ret:
  v_cvt_pk_bf16_f32 v140, v12, v13
  v_cvt_pk_bf16_f32 v141, v14, v15
  v_cvt_pk_bf16_f32 v142, v16, v17
  v_cvt_pk_bf16_f32 v143, v18, v19
  v_exp_f32 v20, v20
  v_exp_f32 v21, v21
  v_exp_f32 v22, v22
  v_exp_f32 v23, v23
  s_waitcnt vmcnt(9)
  v_mfma_f32_32x32x16_bf16 v[44:59], v[200:203], v[140:143], v[44:59]
  v_exp_f32 v24, v24
  v_exp_f32 v25, v25
  v_exp_f32 v26, v26
  v_exp_f32 v27, v27
  v_exp_f32 v28, v28
  v_exp_f32 v29, v29
  v_cvt_pk_bf16_f32 v144, v20, v21
  v_cvt_pk_bf16_f32 v145, v22, v23
  v_cvt_pk_bf16_f32 v146, v24, v25
  v_cvt_pk_bf16_f32 v147, v26, v27
  v_exp_f32 v30, v30
  v_exp_f32 v31, v31
  v_mfma_f32_32x32x16_bf16 v[44:59], v[204:207], v[144:147], v[44:59]
  v_exp_f32 v32, v32
  v_exp_f32 v33, v33
  v_exp_f32 v34, v34
  v_exp_f32 v35, v35
  v_mfma_f32_32x32x16_bf16 v[12:27], v[116:119], v[4:7], v[76:91]
  v_exp_f32 v36, v36
  v_exp_f32 v37, v37
  v_cvt_pk_bf16_f32 v148, v28, v29
  v_cvt_pk_bf16_f32 v149, v30, v31
  v_cvt_pk_bf16_f32 v150, v32, v33
  v_cvt_pk_bf16_f32 v151, v34, v35
  v_exp_f32 v38, v38
  v_exp_f32 v39, v39
  v_mfma_f32_32x32x16_bf16 v[60:75], v[200:203], v[148:151], v[60:75]
  s_cmp_lt_u32 s49, 2
  s_cbranch_scc1 B_gv1
  s_mov_b64 exec, s[52:53]
  buffer_load_dwordx4 v[232:235], v2, s[36:39], s47 offen offset:3072 sc1
  buffer_load_dwordx4 v[236:239], v2, s[36:39], s47 offen offset:3328 sc1
  s_mov_b64 exec, -1
B_gv1:
  v_exp_f32 v40, v40
  v_exp_f32 v41, v41
  v_exp_f32 v42, v42
  v_exp_f32 v43, v43
  v_cvt_pk_bf16_f32 v152, v36, v37
  v_cvt_pk_bf16_f32 v153, v38, v39
  v_cvt_pk_bf16_f32 v154, v40, v41
  v_cvt_pk_bf16_f32 v155, v42, v43
  v_exp_f32 v12, v12
  v_exp_f32 v13, v13
  v_mfma_f32_32x32x16_bf16 v[60:75], v[204:207], v[152:155], v[60:75]
  v_exp_f32 v14, v14
  v_exp_f32 v15, v15
  v_exp_f32 v16, v16
  v_exp_f32 v17, v17
  v_exp_f32 v18, v18
  v_exp_f32 v19, v19
  v_mfma_f32_32x32x16_bf16 v[28:43], v[116:119], v[8:11], v[92:107]
  s_cmp_eq_u32 s49, 1
  s_cbranch_scc1 B_start
B_start_ret:
  buffer_load_dwordx4 v[132:135], v2, s[36:39], s48 offen offset:0 sc1
  v_cvt_pk_bf16_f32 v140, v12, v13
  v_cvt_pk_bf16_f32 v141, v14, v15
  v_cvt_pk_bf16_f32 v142, v16, v17
  v_cvt_pk_bf16_f32 v143, v18, v19
  v_exp_f32 v20, v20
  v_exp_f32 v21, v21
  v_exp_f32 v22, v22
  v_exp_f32 v23, v23
  s_waitcnt vmcnt(9)
  v_mfma_f32_32x32x16_bf16 v[44:59], v[208:211], v[140:143], v[44:59]
  v_exp_f32 v24, v24
  v_exp_f32 v25, v25
  v_exp_f32 v26, v26
  v_exp_f32 v27, v27
  v_exp_f32 v28, v28
  v_exp_f32 v29, v29
  v_cvt_pk_bf16_f32 v144, v20, v21
  v_cvt_pk_bf16_f32 v145, v22, v23
  v_cvt_pk_bf16_f32 v146, v24, v25
  v_cvt_pk_bf16_f32 v147, v26, v27
  v_exp_f32 v30, v30
  v_exp_f32 v31, v31
  v_mfma_f32_32x32x16_bf16 v[44:59], v[212:215], v[144:147], v[44:59]
  v_exp_f32 v32, v32
  v_exp_f32 v33, v33
  v_exp_f32 v34, v34
  v_exp_f32 v35, v35
  v_mfma_f32_32x32x16_bf16 v[12:27], v[120:123], v[4:7], v[76:91]
  v_exp_f32 v36, v36
  v_exp_f32 v37, v37
  v_cvt_pk_bf16_f32 v148, v28, v29
  v_cvt_pk_bf16_f32 v149, v30, v31
  v_cvt_pk_bf16_f32 v150, v32, v33
  v_cvt_pk_bf16_f32 v151, v34, v35
  v_exp_f32 v38, v38
  v_exp_f32 v39, v39
  v_mfma_f32_32x32x16_bf16 v[60:75], v[208:211], v[148:151], v[60:75]
  s_mov_b64 exec, s[52:53]
  buffer_load_dwordx4 v[240:243], v2, s[36:39], s48 offen offset:1024 sc1
  buffer_load_dwordx4 v[244:247], v2, s[36:39], s48 offen offset:1280 sc1
  s_mov_b64 exec, -1
  v_exp_f32 v40, v40
  v_exp_f32 v41, v41
  v_exp_f32 v42, v42
  v_exp_f32 v43, v43
  v_cvt_pk_bf16_f32 v152, v36, v37
  v_cvt_pk_bf16_f32 v153, v38, v39
  v_cvt_pk_bf16_f32 v154, v40, v41
  v_cvt_pk_bf16_f32 v155, v42, v43
  v_exp_f32 v12, v12
  v_exp_f32 v13, v13
  v_mfma_f32_32x32x16_bf16 v[60:75], v[212:215], v[152:155], v[60:75]
  v_exp_f32 v14, v14
  v_exp_f32 v15, v15
  v_exp_f32 v16, v16
  v_exp_f32 v17, v17
  v_exp_f32 v18, v18
  v_exp_f32 v19, v19
  v_mfma_f32_32x32x16_bf16 v[28:43], v[120:123], v[8:11], v[92:107]
  buffer_load_dwordx4 v[136:139], v2, s[36:39], s48 offen offset:2048 sc1
  v_cvt_pk_bf16_f32 v140, v12, v13
  v_cvt_pk_bf16_f32 v141, v14, v15
  v_cvt_pk_bf16_f32 v142, v16, v17
  v_cvt_pk_bf16_f32 v143, v18, v19
  v_exp_f32 v20, v20
  v_exp_f32 v21, v21
  v_exp_f32 v22, v22
  v_exp_f32 v23, v23
  s_waitcnt vmcnt(9)
  v_mfma_f32_32x32x16_bf16 v[44:59], v[216:219], v[140:143], v[44:59]
  v_exp_f32 v24, v24
  v_exp_f32 v25, v25
  v_exp_f32 v26, v26
  v_exp_f32 v27, v27
  v_exp_f32 v28, v28
  v_exp_f32 v29, v29
  v_cvt_pk_bf16_f32 v144, v20, v21
  v_cvt_pk_bf16_f32 v145, v22, v23
  v_cvt_pk_bf16_f32 v146, v24, v25
  v_cvt_pk_bf16_f32 v147, v26, v27
  v_exp_f32 v30, v30
  v_exp_f32 v31, v31
  v_mfma_f32_32x32x16_bf16 v[44:59], v[220:223], v[144:147], v[44:59]
  v_exp_f32 v32, v32
  v_exp_f32 v33, v33
  v_exp_f32 v34, v34
  v_exp_f32 v35, v35
  v_mfma_f32_32x32x16_bf16 v[12:27], v[124:127], v[4:7], v[76:91]
  v_exp_f32 v36, v36
  v_exp_f32 v37, v37
  v_cvt_pk_bf16_f32 v148, v28, v29
  v_cvt_pk_bf16_f32 v149, v30, v31
  v_cvt_pk_bf16_f32 v150, v32, v33
  v_cvt_pk_bf16_f32 v151, v34, v35
  v_exp_f32 v38, v38
  v_exp_f32 v39, v39
  v_mfma_f32_32x32x16_bf16 v[60:75], v[216:219], v[148:151], v[60:75]
  s_mov_b64 exec, s[52:53]
  buffer_load_dwordx4 v[248:251], v2, s[36:39], s48 offen offset:3072 sc1
  buffer_load_dwordx4 v[252:255], v2, s[36:39], s48 offen offset:3328 sc1
  s_mov_b64 exec, -1
  v_exp_f32 v40, v40
  v_exp_f32 v41, v41
  v_exp_f32 v42, v42
  v_exp_f32 v43, v43
  v_cvt_pk_bf16_f32 v152, v36, v37
  v_cvt_pk_bf16_f32 v153, v38, v39
  v_cvt_pk_bf16_f32 v154, v40, v41
  v_cvt_pk_bf16_f32 v155, v42, v43
  v_exp_f32 v12, v12
  v_exp_f32 v13, v13
  v_mfma_f32_32x32x16_bf16 v[60:75], v[220:223], v[152:155], v[60:75]
  v_exp_f32 v14, v14
  v_exp_f32 v15, v15
  v_exp_f32 v16, v16
  v_exp_f32 v17, v17
  v_exp_f32 v18, v18
  v_exp_f32 v19, v19
  v_mfma_f32_32x32x16_bf16 v[28:43], v[124:127], v[8:11], v[92:107]
  s_add_u32 s44, s44, 1
  s_and_b32 s44, s44, 15
  s_bitcmp1_b32 s45, s44
  s_cbranch_scc0 B_poll1
B_pf1:
  s_lshl_b32 s47, s44, 13
  s_add_u32 s47, s47, s46
  s_add_u32 s48, s47, 4096
  buffer_load_dwordx4 v[108:111], v2, s[36:39], s47 offen offset:0 sc1
  v_cvt_pk_bf16_f32 v140, v12, v13
  v_cvt_pk_bf16_f32 v141, v14, v15
  v_cvt_pk_bf16_f32 v142, v16, v17
  v_cvt_pk_bf16_f32 v143, v18, v19
  v_exp_f32 v20, v20
  v_exp_f32 v21, v21
  v_exp_f32 v22, v22
  v_exp_f32 v23, v23
  s_waitcnt vmcnt(9)
  v_mfma_f32_32x32x16_bf16 v[44:59], v[224:227], v[140:143], v[44:59]
  v_exp_f32 v24, v24
  v_exp_f32 v25, v25
  v_exp_f32 v26, v26
  v_exp_f32 v27, v27
  v_exp_f32 v28, v28
  v_exp_f32 v29, v29
  v_cvt_pk_bf16_f32 v144, v20, v21
  v_cvt_pk_bf16_f32 v145, v22, v23
  v_cvt_pk_bf16_f32 v146, v24, v25
  v_cvt_pk_bf16_f32 v147, v26, v27
  v_exp_f32 v30, v30
  v_exp_f32 v31, v31
  v_mfma_f32_32x32x16_bf16 v[44:59], v[228:231], v[144:147], v[44:59]
  v_exp_f32 v32, v32
  v_exp_f32 v33, v33
  v_exp_f32 v34, v34
  v_exp_f32 v35, v35
  v_mfma_f32_32x32x16_bf16 v[12:27], v[128:131], v[4:7], v[76:91]
  v_exp_f32 v36, v36
  v_exp_f32 v37, v37
  v_cvt_pk_bf16_f32 v148, v28, v29
  v_cvt_pk_bf16_f32 v149, v30, v31
  v_cvt_pk_bf16_f32 v150, v32, v33
  v_cvt_pk_bf16_f32 v151, v34, v35
  v_exp_f32 v38, v38
  v_exp_f32 v39, v39
  v_mfma_f32_32x32x16_bf16 v[60:75], v[224:227], v[148:151], v[60:75]
  s_mov_b64 exec, s[52:53]
  buffer_load_dwordx4 v[192:195], v2, s[36:39], s47 offen offset:1024 sc1
  buffer_load_dwordx4 v[196:199], v2, s[36:39], s47 offen offset:1280 sc1
  s_mov_b64 exec, -1
  v_exp_f32 v40, v40
  v_exp_f32 v41, v41
  v_exp_f32 v42, v42
  v_exp_f32 v43, v43
  v_cvt_pk_bf16_f32 v152, v36, v37
  v_cvt_pk_bf16_f32 v153, v38, v39
  v_cvt_pk_bf16_f32 v154, v40, v41
  v_cvt_pk_bf16_f32 v155, v42, v43
  v_exp_f32 v12, v12
  v_exp_f32 v13, v13
  v_mfma_f32_32x32x16_bf16 v[60:75], v[228:231], v[152:155], v[60:75]
  v_exp_f32 v14, v14
  v_exp_f32 v15, v15
  v_exp_f32 v16, v16
  v_exp_f32 v17, v17
  v_exp_f32 v18, v18
  v_exp_f32 v19, v19
  v_mfma_f32_32x32x16_bf16 v[28:43], v[128:131], v[8:11], v[92:107]
  buffer_load_dwordx4 v[112:115], v2, s[36:39], s47 offen offset:2048 sc1
  v_cvt_pk_bf16_f32 v140, v12, v13
  v_cvt_pk_bf16_f32 v141, v14, v15
  v_cvt_pk_bf16_f32 v142, v16, v17
  v_cvt_pk_bf16_f32 v143, v18, v19
  v_exp_f32 v20, v20
  v_exp_f32 v21, v21
  v_exp_f32 v22, v22
  v_exp_f32 v23, v23
  s_waitcnt vmcnt(9)
  v_mfma_f32_32x32x16_bf16 v[44:59], v[232:235], v[140:143], v[44:59]
  v_exp_f32 v24, v24
  v_exp_f32 v25, v25
  v_exp_f32 v26, v26
  v_exp_f32 v27, v27
  v_exp_f32 v28, v28
  v_exp_f32 v29, v29
  v_cvt_pk_bf16_f32 v144, v20, v21
  v_cvt_pk_bf16_f32 v145, v22, v23
  v_cvt_pk_bf16_f32 v146, v24, v25
  v_cvt_pk_bf16_f32 v147, v26, v27
  v_exp_f32 v30, v30
  v_exp_f32 v31, v31
  v_mfma_f32_32x32x16_bf16 v[44:59], v[236:239], v[144:147], v[44:59]
  v_exp_f32 v32, v32
  v_exp_f32 v33, v33
  v_exp_f32 v34, v34
  v_exp_f32 v35, v35
  v_mfma_f32_32x32x16_bf16 v[12:27], v[132:135], v[4:7], v[76:91]
  v_exp_f32 v36, v36
  v_exp_f32 v37, v37
  v_cvt_pk_bf16_f32 v148, v28, v29
  v_cvt_pk_bf16_f32 v149, v30, v31
  v_cvt_pk_bf16_f32 v150, v32, v33
  v_cvt_pk_bf16_f32 v151, v34, v35
  v_exp_f32 v38, v38
  v_exp_f32 v39, v39
  v_mfma_f32_32x32x16_bf16 v[60:75], v[232:235], v[148:151], v[60:75]
  s_mov_b64 exec, s[52:53]
  buffer_load_dwordx4 v[200:203], v2, s[36:39], s47 offen offset:3072 sc1
  buffer_load_dwordx4 v[204:207], v2, s[36:39], s47 offen offset:3328 sc1
  s_mov_b64 exec, -1
  v_exp_f32 v40, v40
  v_exp_f32 v41, v41
  v_exp_f32 v42, v42
  v_exp_f32 v43, v43
  v_cvt_pk_bf16_f32 v152, v36, v37
  v_cvt_pk_bf16_f32 v153, v38, v39
  v_cvt_pk_bf16_f32 v154, v40, v41
  v_cvt_pk_bf16_f32 v155, v42, v43
  v_exp_f32 v12, v12
  v_exp_f32 v13, v13
  v_mfma_f32_32x32x16_bf16 v[60:75], v[236:239], v[152:155], v[60:75]
  v_exp_f32 v14, v14
  v_exp_f32 v15, v15
  v_exp_f32 v16, v16
  v_exp_f32 v17, v17
  v_exp_f32 v18, v18
  v_exp_f32 v19, v19
  v_mfma_f32_32x32x16_bf16 v[28:43], v[132:135], v[8:11], v[92:107]
  buffer_load_dwordx4 v[116:119], v2, s[36:39], s48 offen offset:0 sc1
  v_cvt_pk_bf16_f32 v140, v12, v13
  v_cvt_pk_bf16_f32 v141, v14, v15
  v_cvt_pk_bf16_f32 v142, v16, v17
  v_cvt_pk_bf16_f32 v143, v18, v19
  v_exp_f32 v20, v20
  v_exp_f32 v21, v21
  v_exp_f32 v22, v22
  v_exp_f32 v23, v23
  s_waitcnt vmcnt(9)
  v_mfma_f32_32x32x16_bf16 v[44:59], v[240:243], v[140:143], v[44:59]
  v_exp_f32 v24, v24
  v_exp_f32 v25, v25
  v_exp_f32 v26, v26
  v_exp_f32 v27, v27
  v_exp_f32 v28, v28
  v_exp_f32 v29, v29
  v_cvt_pk_bf16_f32 v144, v20, v21
  v_cvt_pk_bf16_f32 v145, v22, v23
  v_cvt_pk_bf16_f32 v146, v24, v25
  v_cvt_pk_bf16_f32 v147, v26, v27
  v_exp_f32 v30, v30
  v_exp_f32 v31, v31
  v_mfma_f32_32x32x16_bf16 v[44:59], v[244:247], v[144:147], v[44:59]
  v_exp_f32 v32, v32
  v_exp_f32 v33, v33
  v_exp_f32 v34, v34
  v_exp_f32 v35, v35
  v_mfma_f32_32x32x16_bf16 v[12:27], v[136:139], v[4:7], v[76:91]
  v_exp_f32 v36, v36
  v_exp_f32 v37, v37
  v_cvt_pk_bf16_f32 v148, v28, v29
  v_cvt_pk_bf16_f32 v149, v30, v31
  v_cvt_pk_bf16_f32 v150, v32, v33
  v_cvt_pk_bf16_f32 v151, v34, v35
  v_exp_f32 v38, v38
  v_exp_f32 v39, v39
  v_mfma_f32_32x32x16_bf16 v[60:75], v[240:243], v[148:151], v[60:75]
  s_mov_b64 exec, s[52:53]
  buffer_load_dwordx4 v[208:211], v2, s[36:39], s48 offen offset:1024 sc1
  buffer_load_dwordx4 v[212:215], v2, s[36:39], s48 offen offset:1280 sc1
  s_mov_b64 exec, -1
  v_exp_f32 v40, v40
  v_exp_f32 v41, v41
  v_exp_f32 v42, v42
  v_exp_f32 v43, v43
  v_cvt_pk_bf16_f32 v152, v36, v37
  v_cvt_pk_bf16_f32 v153, v38, v39
  v_cvt_pk_bf16_f32 v154, v40, v41
  v_cvt_pk_bf16_f32 v155, v42, v43
  v_exp_f32 v12, v12
  v_exp_f32 v13, v13
  v_mfma_f32_32x32x16_bf16 v[60:75], v[244:247], v[152:155], v[60:75]
  v_exp_f32 v14, v14
  v_exp_f32 v15, v15
  v_exp_f32 v16, v16
  v_exp_f32 v17, v17
  v_exp_f32 v18, v18
  v_exp_f32 v19, v19
  v_mfma_f32_32x32x16_bf16 v[28:43], v[136:139], v[8:11], v[92:107]
  buffer_load_dwordx4 v[120:123], v2, s[36:39], s48 offen offset:2048 sc1
  v_cvt_pk_bf16_f32 v140, v12, v13
  v_cvt_pk_bf16_f32 v141, v14, v15
  v_cvt_pk_bf16_f32 v142, v16, v17
  v_cvt_pk_bf16_f32 v143, v18, v19
  v_exp_f32 v20, v20
  v_exp_f32 v21, v21
  v_exp_f32 v22, v22
  v_exp_f32 v23, v23
  s_waitcnt vmcnt(9)
  v_mfma_f32_32x32x16_bf16 v[44:59], v[248:251], v[140:143], v[44:59]
  v_exp_f32 v24, v24
  v_exp_f32 v25, v25
  v_exp_f32 v26, v26
  v_exp_f32 v27, v27
  v_exp_f32 v28, v28
  v_exp_f32 v29, v29
  v_cvt_pk_bf16_f32 v144, v20, v21
  v_cvt_pk_bf16_f32 v145, v22, v23
  v_cvt_pk_bf16_f32 v146, v24, v25
  v_cvt_pk_bf16_f32 v147, v26, v27
  v_exp_f32 v30, v30
  v_exp_f32 v31, v31
  v_mfma_f32_32x32x16_bf16 v[44:59], v[252:255], v[144:147], v[44:59]
  v_exp_f32 v32, v32
  v_exp_f32 v33, v33
  v_exp_f32 v34, v34
  v_exp_f32 v35, v35
  v_mfma_f32_32x32x16_bf16 v[12:27], v[108:111], v[4:7], v[76:91]
  v_exp_f32 v36, v36
  v_exp_f32 v37, v37
  v_cvt_pk_bf16_f32 v148, v28, v29
  v_cvt_pk_bf16_f32 v149, v30, v31
  v_cvt_pk_bf16_f32 v150, v32, v33
  v_cvt_pk_bf16_f32 v151, v34, v35
  v_exp_f32 v38, v38
  v_exp_f32 v39, v39
  v_mfma_f32_32x32x16_bf16 v[60:75], v[248:251], v[148:151], v[60:75]
  s_mov_b64 exec, s[52:53]
  buffer_load_dwordx4 v[216:219], v2, s[36:39], s48 offen offset:3072 sc1
  buffer_load_dwordx4 v[220:223], v2, s[36:39], s48 offen offset:3328 sc1
  s_mov_b64 exec, -1
  s_cmp_lt_u32 s50, 4
  s_cbranch_scc1 B_wo
B_wo_ret:
  v_exp_f32 v40, v40
  v_exp_f32 v41, v41
  v_exp_f32 v42, v42
  v_exp_f32 v43, v43
  v_cvt_pk_bf16_f32 v152, v36, v37
  v_cvt_pk_bf16_f32 v153, v38, v39
  v_cvt_pk_bf16_f32 v154, v40, v41
  v_cvt_pk_bf16_f32 v155, v42, v43
  s_add_u32 s55, s55, 1
  s_cmp_lt_u32 s55, 5
  s_cbranch_scc1 B_noprio
  s_setprio 2
  s_cmp_eq_u32 s55, 5
  s_cbranch_scc1 B_noprio
  s_setprio 1
  s_cmp_eq_u32 s55, 6
  s_cbranch_scc1 B_noprio
  s_setprio 0
B_noprio:
  s_cmp_ge_u32 s55, 5
  s_cbranch_scc1 B_wobar
B_wobar_ret:
  s_cmp_lt_u32 s55, 8
  s_cbranch_scc1 B_loop
  s_nop 1
  v_mfma_f32_32x32x16_bf16 v[60:75], v[252:255], v[152:155], v[60:75]
  s_nop 7
  s_nop 7
  s_cmp_lg_u32 s54, 0
  s_cbranch_scc1 B_fin
  v_mov_b32 v158, 0
  v_mov_b32 v159, 0
  v_max3_f32 v158, v158, |v44|, |v45|
  v_max3_f32 v158, v158, |v46|, |v47|
  v_max3_f32 v158, v158, |v48|, |v49|
  v_max3_f32 v158, v158, |v50|, |v51|
  v_max_f32 v158, v158, v52
  v_add_f32 v159, v159, v44
  v_add_f32 v159, v159, v45
  v_add_f32 v159, v159, v46
  v_add_f32 v159, v159, v47
  v_add_f32 v159, v159, v48
  v_add_f32 v159, v159, v49
  v_add_f32 v159, v159, v50
  v_add_f32 v159, v159, v51
  v_max3_f32 v158, v158, |v60|, |v61|
  v_max3_f32 v158, v158, |v62|, |v63|
  v_max3_f32 v158, v158, |v64|, |v65|
  v_max3_f32 v158, v158, |v66|, |v67|
  v_max_f32 v158, v158, v68
  v_add_f32 v159, v159, v60
  v_add_f32 v159, v159, v61
  v_add_f32 v159, v159, v62
  v_add_f32 v159, v159, v63
  v_add_f32 v159, v159, v64
  v_add_f32 v159, v159, v65
  v_add_f32 v159, v159, v66
  v_add_f32 v159, v159, v67
  v_mul_f32 v159, 0, v159
  v_add_f32 v158, v158, v159
  s_mov_b32 s57, 0x71800000
  v_cmp_gt_f32 vcc, s57, v158
  s_cmp_eq_u64 vcc, exec
  s_cbranch_scc1 B_fin
  s_mov_b32 s54, 1
  v_mov_b32 v158, 0xff61b1e6
  v_mov_b32 v159, 0xff61b1e6
  s_mov_b32 s47, s46
  s_mov_b32 s55, 0
  s_waitcnt vmcnt(0)
B_maxloop:
  buffer_load_dwordx4 v[124:127], v2, s[36:39], s47 offen sc1
  s_waitcnt vmcnt(0)
  v_mfma_f32_32x32x16_bf16 v[12:27], v[124:127], v[4:7], 0
  v_mfma_f32_32x32x16_bf16 v[28:43], v[124:127], v[8:11], 0
  s_nop 7
  s_nop 7
  v_max3_f32 v158, v158, v12, v13
  v_max3_f32 v158, v158, v14, v15
  v_max3_f32 v158, v158, v16, v17
  v_max3_f32 v158, v158, v18, v19
  v_max3_f32 v158, v158, v20, v21
  v_max3_f32 v158, v158, v22, v23
  v_max3_f32 v158, v158, v24, v25
  v_max3_f32 v158, v158, v26, v27
  v_max3_f32 v159, v159, v28, v29
  v_max3_f32 v159, v159, v30, v31
  v_max3_f32 v159, v159, v32, v33
  v_max3_f32 v159, v159, v34, v35
  v_max3_f32 v159, v159, v36, v37
  v_max3_f32 v159, v159, v38, v39
  v_max3_f32 v159, v159, v40, v41
  v_max3_f32 v159, v159, v42, v43
  s_add_u32 s47, s47, 2048
  s_add_u32 s55, s55, 1
  s_cmp_lt_u32 s55, 64
  s_cbranch_scc1 B_maxloop
  s_branch B_setmax
B_late0:
  s_branch B_late0_ret
B_late1:
  s_cmp_lg_u32 s49, 0
  s_cbranch_scc1 B_late1_ret
  s_branch B_first
B_start:
  s_add_u32 s44, s44, 1
  s_and_b32 s44, s44, 15
  s_bitcmp1_b32 s45, s44
  s_cbranch_scc0 B_poll2
B_pf2:
  s_lshl_b32 s47, s44, 13
  s_add_u32 s47, s47, s46
  s_add_u32 s48, s47, 4096
  buffer_load_dwordx4 v[124:127], v2, s[36:39], s47 offen offset:0 sc1
  s_mov_b64 exec, s[52:53]
  buffer_load_dwordx4 v[224:227], v2, s[36:39], s47 offen offset:1024 sc1
  buffer_load_dwordx4 v[228:231], v2, s[36:39], s47 offen offset:1280 sc1
  s_mov_b64 exec, -1
  buffer_load_dwordx4 v[128:131], v2, s[36:39], s47 offen offset:2048 sc1
  s_mov_b64 exec, s[52:53]
  buffer_load_dwordx4 v[232:235], v2, s[36:39], s47 offen offset:3072 sc1
  buffer_load_dwordx4 v[236:239], v2, s[36:39], s47 offen offset:3328 sc1
  s_mov_b64 exec, -1
  s_mov_b32 s49, 2
  s_branch B_start_ret
B_first:
  s_waitcnt vmcnt(0)
  s_barrier
  s_mov_b32 s49, 1
  s_cmp_lg_u32 s3, 0
  s_cbranch_scc1 B_late1_ret
  s_lshl_b32 s40, s26, 7
  s_lshl_b32 s41, s27, 2
  s_add_u32 s40, s40, s41
  s_add_u32 s40, s40, 16777216
  v_mov_b32 v160, 0
  v_mov_b32 v161, s68
  s_mov_b64 exec, 1
  buffer_store_dword v161, v160, s[36:39], s40 offen sc1
  s_lshl_b32 s40, s27, 7
  s_lshl_b32 s41, s26, 2
  s_add_u32 s40, s40, s41
  s_add_u32 s40, s40, 16787456
  buffer_store_dword v161, v160, s[36:39], s40 offen sc1
  s_mov_b64 exec, -1
  s_branch B_late1_ret
B_wobar:
  s_cmp_lg_u32 s54, 0
  s_cbranch_scc1 B_wobar_ret
  s_cmp_eq_u32 s55, 6
  s_cbranch_scc1 B_wobar6
  s_cmp_lg_u32 s55, 5
  s_cbranch_scc1 B_wobar_ret
  s_cmp_lg_u32 s3, 0
  s_cbranch_scc1 B_wobar_ret
  s_lshl_b32 s40, s27, 7
  s_add_u32 s40, s40, 16787456
  v_lshlrev_b32 v160, 2, v1
  s_mov_b32 s69, 0
B_gpoll:
  s_mov_b64 exec, 0xffff
  buffer_load_dword v161, v160, s[36:39], s40 offen sc1
  s_add_u32 s69, s69, 1
  s_waitcnt vmcnt(0)
  v_cmp_eq_u32 vcc, s68, v161
  s_mov_b64 exec, -1
  s_cmp_eq_u32 vcc_lo, 0xffff
  s_cbranch_scc1 B_wobar_ret
  s_cmp_lt_u32 s69, 200000
  s_cbranch_scc1 B_gpoll
  s_branch B_wobar_ret
B_wobar6:
  s_barrier
  s_lshl_b32 s40, s33, 7
  s_add_u32 s40, s40, 16789504
  v_and_b32 v160, 31, v1
  v_lshlrev_b32 v160, 2, v160
  buffer_load_dword v156, v160, s[36:39], s40 offen sc1
  buffer_load_dword v157, v160, s[36:39], s40 offen offset:128 sc1
  s_branch B_wobar_ret
B_wo:
  s_add_u32 m0, s58, 0
  s_add_u32 s51, s59, 0
  buffer_load_dwordx4 v162, s[60:63], s51 offen lds
  s_add_u32 m0, s58, 1024
  s_add_u32 s51, s59, 8192
  buffer_load_dwordx4 v162, s[60:63], s51 offen lds
  s_add_u32 m0, s58, 2048
  s_add_u32 s51, s59, 16384
  buffer_load_dwordx4 v162, s[60:63], s51 offen lds
  s_add_u32 m0, s58, 3072
  s_add_u32 s51, s59, 24576
  buffer_load_dwordx4 v162, s[60:63], s51 offen lds
  s_add_u32 s58, s58, 4096
  s_add_u32 s59, s59, 32768
  s_add_u32 s50, s50, 1
  s_branch B_wo_ret
B_poll0:
  s_mov_b32 s69, 0
  s_cmp_lg_u32 s3, 0
  s_cbranch_scc1 B_lp0
  s_lshl_b32 s40, s26, 7
  s_add_u32 s40, s40, 16777216
  v_lshlrev_b32 v160, 2, v1
B_gp0:
  s_mov_b64 exec, 0xffff
  buffer_load_dword v161, v160, s[36:39], s40 offen sc1
  s_add_u32 s69, s69, 1
  s_waitcnt vmcnt(0)
  v_cmp_eq_u32 vcc, s68, v161
  s_mov_b64 exec, -1
  s_or_b32 s45, s45, vcc_lo
  s_bitcmp1_b32 s45, s44
  s_cbranch_scc1 B_gok0
  s_cmp_lt_u32 s69, 200000
  s_cbranch_scc1 B_gp0
  s_mov_b32 s45, 0xffff
B_gok0:
  v_mov_b32 v160, 160004
  v_mov_b32 v161, s45
  ds_write_b32 v160, v161
  s_branch B_pf0
B_lp0:
  v_mov_b32 v160, 160004
B_lpl0:
  ds_read_b32 v161, v160
  s_add_u32 s69, s69, 1
  s_waitcnt lgkmcnt(0)
  v_readfirstlane_b32 s40, v161
  s_nop 3
  s_or_b32 s45, s45, s40
  s_bitcmp1_b32 s45, s44
  s_cbranch_scc1 B_pf0
  s_cmp_lt_u32 s69, 4000000
  s_cbranch_scc1 B_lpl0
  s_mov_b32 s45, 0xffff
  s_branch B_pf0
B_poll1:
  s_mov_b32 s69, 0
  s_cmp_lg_u32 s3, 0
  s_cbranch_scc1 B_lp1
  s_lshl_b32 s40, s26, 7
  s_add_u32 s40, s40, 16777216
  v_lshlrev_b32 v160, 2, v1
B_gp1:
  s_mov_b64 exec, 0xffff
  buffer_load_dword v161, v160, s[36:39], s40 offen sc1
  s_add_u32 s69, s69, 1
  s_waitcnt vmcnt(0)
  v_cmp_eq_u32 vcc, s68, v161
  s_mov_b64 exec, -1
  s_or_b32 s45, s45, vcc_lo
  s_bitcmp1_b32 s45, s44
  s_cbranch_scc1 B_gok1
  s_cmp_lt_u32 s69, 200000
  s_cbranch_scc1 B_gp1
  s_mov_b32 s45, 0xffff
B_gok1:
  v_mov_b32 v160, 160004
  v_mov_b32 v161, s45
  ds_write_b32 v160, v161
  s_branch B_pf1
B_lp1:
  v_mov_b32 v160, 160004
B_lpl1:
  ds_read_b32 v161, v160
  s_add_u32 s69, s69, 1
  s_waitcnt lgkmcnt(0)
  v_readfirstlane_b32 s40, v161
  s_nop 3
  s_or_b32 s45, s45, s40
  s_bitcmp1_b32 s45, s44
  s_cbranch_scc1 B_pf1
  s_cmp_lt_u32 s69, 4000000
  s_cbranch_scc1 B_lpl1
  s_mov_b32 s45, 0xffff
  s_branch B_pf1
B_poll2:
  s_mov_b32 s69, 0
  s_cmp_lg_u32 s3, 0
  s_cbranch_scc1 B_lp2
  s_lshl_b32 s40, s26, 7
  s_add_u32 s40, s40, 16777216
  v_lshlrev_b32 v160, 2, v1
B_gp2:
  s_mov_b64 exec, 0xffff
  buffer_load_dword v161, v160, s[36:39], s40 offen sc1
  s_add_u32 s69, s69, 1
  s_waitcnt vmcnt(0)
  v_cmp_eq_u32 vcc, s68, v161
  s_mov_b64 exec, -1
  s_or_b32 s45, s45, vcc_lo
  s_bitcmp1_b32 s45, s44
  s_cbranch_scc1 B_gok2
  s_cmp_lt_u32 s69, 200000
  s_cbranch_scc1 B_gp2
  s_mov_b32 s45, 0xffff
B_gok2:
  v_mov_b32 v160, 160004
  v_mov_b32 v161, s45
  ds_write_b32 v160, v161
  s_branch B_pf2
B_lp2:
  v_mov_b32 v160, 160004
B_lpl2:
  ds_read_b32 v161, v160
  s_add_u32 s69, s69, 1
  s_waitcnt lgkmcnt(0)
  v_readfirstlane_b32 s40, v161
  s_nop 3
  s_or_b32 s45, s45, s40
  s_bitcmp1_b32 s45, s44
  s_cbranch_scc1 B_pf2
  s_cmp_lt_u32 s69, 4000000
  s_cbranch_scc1 B_lpl2
  s_mov_b32 s45, 0xffff
  s_branch B_pf2
B_fin:
  s_waitcnt vmcnt(0)
  s_cmp_eq_u32 s28, 0
  s_cbranch_scc1 B_fin2
  v_sub_f32 v156, 1.0, v156
  v_sub_f32 v157, 1.0, v157
B_fin2:
  v_rcp_f32 v158, v52
  s_nop 0
  v_mul_f32 v158, v158, v156
  v_mul_f32 v44, v44, v158
  v_mul_f32 v45, v45, v158
  v_mul_f32 v46, v46, v158
  v_mul_f32 v47, v47, v158
  v_mul_f32 v48, v48, v158
  v_mul_f32 v49, v49, v158
  v_mul_f32 v50, v50, v158
  v_mul_f32 v51, v51, v158
  v_cvt_pk_bf16_f32 v44, v44, v45
  v_cvt_pk_bf16_f32 v45, v46, v47
  v_cvt_pk_bf16_f32 v46, v48, v49
  v_cvt_pk_bf16_f32 v47, v50, v51
  v_rcp_f32 v158, v68
  s_nop 0
  v_mul_f32 v158, v158, v157
  v_mul_f32 v60, v60, v158
  v_mul_f32 v61, v61, v158
  v_mul_f32 v62, v62, v158
  v_mul_f32 v63, v63, v158
  v_mul_f32 v64, v64, v158
  v_mul_f32 v65, v65, v158
  v_mul_f32 v66, v66, v158
  v_mul_f32 v67, v67, v158
  v_cvt_pk_bf16_f32 v60, v60, v61
  v_cvt_pk_bf16_f32 v61, v62, v63
  v_cvt_pk_bf16_f32 v62, v64, v65
  v_cvt_pk_bf16_f32 v63, v66, v67
  s_lshl_b32 s40, s33, 6
  s_add_u32 s40, s40, s32
  s_lshl_b32 s40, s40, 10
  s_add_u32 s40, s40, 12582912
  s_add_u32 s41, s40, 65536
  buffer_store_dwordx4 v[44:47], v2, s[36:39], s40 offen sc1
  buffer_store_dwordx4 v[60:63], v2, s[36:39], s41 offen sc1
  s_waitcnt vmcnt(0)
  s_barrier
  s_cmp_lg_u32 s3, 0
  s_cbranch_scc1 B_opub_done
  s_lshl_b32 s40, s27, 9
  s_lshl_b32 s41, s26, 2
  s_add_u32 s40, s40, s41
  s_add_u32 s40, s40, 16779264
  v_mov_b32 v4, 0
  v_mov_b32 v5, s68
  s_mov_b64 exec, 1
  buffer_store_dword v5, v4, s[36:39], s40 offen sc1
  s_mov_b64 exec, -1
B_opub_done:
  s_lshl_b32 s30, s27, 1
  s_lshr_b32 s40, s26, 3
  s_add_u32 s30, s30, s40
  s_and_b32 s31, s26, 7
  s_lshr_b32 s32, s3, 1
  s_and_b32 s33, s3, 1
  v_lshrrev_b32 v5, 4, v1
  v_lshrrev_b32 v21, 5, v1
  v_and_b32 v26, 15, v1
  v_lshrrev_b32 v27, 2, v26
  v_lshl_add_u32 v28, v21, 2, v27
  v_lshlrev_b32 v28, 7, v28
  v_and_b32 v29, 1, v5
  v_lshlrev_b32 v29, 1, v29
  v_bfe_u32 v30, v26, 1, 1
  v_add_u32 v29, v29, v30
  v_bfe_u32 v30, v27, 1, 1
  v_lshlrev_b32 v30, 2, v30
  v_xor_b32 v29, v29, v30
  v_lshl_add_u32 v28, v29, 4, v28
  v_and_b32 v30, 1, v26
  v_lshl_add_u32 v28, v30, 3, v28
  s_lshl_b32 s40, s32, 15
  v_add_u32 v20, s40, v28
  v_xor_b32 v23, 64, v20
  ds_read_b64_tr_b16 v[160:161], v20 offset:0
  ds_read_b64_tr_b16 v[162:163], v20 offset:1024
  ds_read_b64_tr_b16 v[164:165], v23 offset:0
  ds_read_b64_tr_b16 v[166:167], v23 offset:1024
  ds_read_b64_tr_b16 v[168:169], v20 offset:2048
  ds_read_b64_tr_b16 v[170:171], v20 offset:3072
  ds_read_b64_tr_b16 v[172:173], v23 offset:2048
  ds_read_b64_tr_b16 v[174:175], v23 offset:3072
  ds_read_b64_tr_b16 v[176:177], v20 offset:4096
  ds_read_b64_tr_b16 v[178:179], v20 offset:5120
  ds_read_b64_tr_b16 v[180:181], v23 offset:4096
  ds_read_b64_tr_b16 v[182:183], v23 offset:5120
  ds_read_b64_tr_b16 v[184:185], v20 offset:6144
  ds_read_b64_tr_b16 v[186:187], v20 offset:7168
  ds_read_b64_tr_b16 v[188:189], v23 offset:6144
  ds_read_b64_tr_b16 v[190:191], v23 offset:7168
  ds_read_b64_tr_b16 v[192:193], v20 offset:8192
  ds_read_b64_tr_b16 v[194:195], v20 offset:9216
  ds_read_b64_tr_b16 v[196:197], v23 offset:8192
  ds_read_b64_tr_b16 v[198:199], v23 offset:9216
  ds_read_b64_tr_b16 v[200:201], v20 offset:10240
  ds_read_b64_tr_b16 v[202:203], v20 offset:11264
  ds_read_b64_tr_b16 v[204:205], v23 offset:10240
  ds_read_b64_tr_b16 v[206:207], v23 offset:11264
  ds_read_b64_tr_b16 v[208:209], v20 offset:12288
  ds_read_b64_tr_b16 v[210:211], v20 offset:13312
  ds_read_b64_tr_b16 v[212:213], v23 offset:12288
  ds_read_b64_tr_b16 v[214:215], v23 offset:13312
  ds_read_b64_tr_b16 v[216:217], v20 offset:14336
  ds_read_b64_tr_b16 v[218:219], v20 offset:15360
  ds_read_b64_tr_b16 v[220:221], v23 offset:14336
  ds_read_b64_tr_b16 v[222:223], v23 offset:15360
  ds_read_b64_tr_b16 v[224:225], v20 offset:16384
  ds_read_b64_tr_b16 v[226:227], v20 offset:17408
  ds_read_b64_tr_b16 v[228:229], v23 offset:16384
  ds_read_b64_tr_b16 v[230:231], v23 offset:17408
  ds_read_b64_tr_b16 v[232:233], v20 offset:18432
  ds_read_b64_tr_b16 v[234:235], v20 offset:19456
  ds_read_b64_tr_b16 v[236:237], v23 offset:18432
  ds_read_b64_tr_b16 v[238:239], v23 offset:19456
  ds_read_b64_tr_b16 v[240:241], v20 offset:20480
  ds_read_b64_tr_b16 v[242:243], v20 offset:21504
  ds_read_b64_tr_b16 v[244:245], v23 offset:20480
  ds_read_b64_tr_b16 v[246:247], v23 offset:21504
  ds_read_b64_tr_b16 v[248:249], v20 offset:22528
  ds_read_b64_tr_b16 v[250:251], v20 offset:23552
  ds_read_b64_tr_b16 v[252:253], v23 offset:22528
  ds_read_b64_tr_b16 v[254:255], v23 offset:23552
  ds_read_b64_tr_b16 v[32:33], v20 offset:24576
  ds_read_b64_tr_b16 v[34:35], v20 offset:25600
  ds_read_b64_tr_b16 v[36:37], v23 offset:24576
  ds_read_b64_tr_b16 v[38:39], v23 offset:25600
  ds_read_b64_tr_b16 v[40:41], v20 offset:26624
  ds_read_b64_tr_b16 v[42:43], v20 offset:27648
  ds_read_b64_tr_b16 v[44:45], v23 offset:26624
  ds_read_b64_tr_b16 v[46:47], v23 offset:27648
  ds_read_b64_tr_b16 v[48:49], v20 offset:28672
  ds_read_b64_tr_b16 v[50:51], v20 offset:29696
  ds_read_b64_tr_b16 v[52:53], v23 offset:28672
  ds_read_b64_tr_b16 v[54:55], v23 offset:29696
  ds_read_b64_tr_b16 v[56:57], v20 offset:30720
  ds_read_b64_tr_b16 v[58:59], v20 offset:31744
  ds_read_b64_tr_b16 v[60:61], v23 offset:30720
  ds_read_b64_tr_b16 v[62:63], v23 offset:31744
  v_lshlrev_b32 v6, 2, v1
  s_lshl_b32 s45, s30, 1
  s_add_u32 s45, s45, s33
  s_lshl_b32 s45, s45, 6
  s_lshl_b32 s46, s32, 4
  s_add_u32 s45, s45, s46
  s_lshl_b32 s45, s45, 10
  s_add_u32 s45, s45, 12582912
  s_lshl_b32 s44, s27, 9
  s_add_u32 s44, s44, 16779264
  s_lshl_b32 s50, s32, 2
  s_lshl_b32 s51, 1, s26
  s_mov_b32 s47, s51
  v_mov_b32 v8, 160008
  s_mov_b32 s69, 0
  v_and_b32 v24, 31, v1
  v_and_b32 v25, 7, v24
  v_lshlrev_b32 v24, 8, v24
  s_lshl_b32 s40, s32, 14
  s_lshl_b32 s41, s33, 13
  s_add_u32 s40, s40, s41
  v_add_u32 v24, s40, v24
  v_add_u32 v26, 0, v21
  v_xor_b32 v26, v26, v25
  v_lshl_add_u32 v10, v26, 4, v24
  v_add_u32 v26, 2, v21
  v_xor_b32 v26, v26, v25
  v_lshl_add_u32 v11, v26, 4, v24
  v_add_u32 v26, 4, v21
  v_xor_b32 v26, v26, v25
  v_lshl_add_u32 v12, v26, 4, v24
  v_add_u32 v26, 6, v21
  v_xor_b32 v26, v26, v25
  v_lshl_add_u32 v13, v26, 4, v24
  v_add_u32 v26, 8, v21
  v_xor_b32 v26, v26, v25
  v_lshl_add_u32 v14, v26, 4, v24
  v_add_u32 v26, 10, v21
  v_xor_b32 v26, v26, v25
  v_lshl_add_u32 v15, v26, 4, v24
  v_add_u32 v26, 12, v21
  v_xor_b32 v26, v26, v25
  v_lshl_add_u32 v16, v26, 4, v24
  v_add_u32 v26, 14, v21
  v_xor_b32 v26, v26, v25
  v_lshl_add_u32 v17, v26, 4, v24
  v_lshrrev_b32 v24, 3, v0
  v_and_b32 v25, 7, v0
  v_and_b32 v26, 7, v24
  v_lshlrev_b32 v27, 8, v24
  v_lshlrev_b32 v28, 1, v25
  v_xor_b32 v29, v28, v26
  v_lshl_add_u32 v18, v29, 4, v27
  v_add_u32 v28, 1, v28
  v_xor_b32 v29, v28, v26
  v_lshl_add_u32 v19, v29, 4, v27
  v_lshlrev_b32 v22, 10, v24
  v_lshl_add_u32 v22, v25, 4, v22
  s_mov_b32 s60, s18
  s_mov_b32 s61, s19
  s_mov_b32 s62, 2097152
  s_mov_b32 s63, 0x20000
  s_lshl_b32 s48, s30, 16
  s_lshl_b32 s41, s31, 7
  s_add_u32 s48, s48, s41
  s_cmp_eq_u32 s3, 7
  s_cbranch_scc1 C_poller
C_lw0:
  s_bitcmp1_b32 s47, s50
  s_cbranch_scc1 C_lr0
  ds_read_b32 v9, v8
  s_add_u32 s69, s69, 1
  s_waitcnt lgkmcnt(0)
  v_readfirstlane_b32 s47, v9
  s_nop 3
  s_or_b32 s47, s47, s51
  s_cmp_lt_u32 s69, 4000000
  s_cbranch_scc1 C_lw0
C_lr0:
  buffer_load_dwordx4 v[64:67], v2, s[36:39], s45 offen offset:0 sc1
  buffer_load_dwordx4 v[68:71], v2, s[36:39], s45 offen offset:1024 sc1
  buffer_load_dwordx4 v[72:75], v2, s[36:39], s45 offen offset:2048 sc1
  buffer_load_dwordx4 v[76:79], v2, s[36:39], s45 offen offset:3072 sc1
  s_add_u32 s45, s45, 4096
  s_add_u32 s50, s50, 1
C_lw1:
  s_bitcmp1_b32 s47, s50
  s_cbranch_scc1 C_lr1
  ds_read_b32 v9, v8
  s_add_u32 s69, s69, 1
  s_waitcnt lgkmcnt(0)
  v_readfirstlane_b32 s47, v9
  s_nop 3
  s_or_b32 s47, s47, s51
  s_cmp_lt_u32 s69, 4000000
  s_cbranch_scc1 C_lw1
C_lr1:
  buffer_load_dwordx4 v[80:83], v2, s[36:39], s45 offen offset:0 sc1
  buffer_load_dwordx4 v[84:87], v2, s[36:39], s45 offen offset:1024 sc1
  buffer_load_dwordx4 v[88:91], v2, s[36:39], s45 offen offset:2048 sc1
  buffer_load_dwordx4 v[92:95], v2, s[36:39], s45 offen offset:3072 sc1
  s_add_u32 s45, s45, 4096
  s_add_u32 s50, s50, 1
  s_waitcnt vmcnt(4) lgkmcnt(0)
  v_mfma_f32_32x32x16_bf16 v[128:143], v[160:163], v[64:67], 0
  v_mfma_f32_32x32x16_bf16 v[144:159], v[164:167], v[64:67], 0
  v_mfma_f32_32x32x16_bf16 v[128:143], v[168:171], v[68:71], v[128:143]
  v_mfma_f32_32x32x16_bf16 v[144:159], v[172:175], v[68:71], v[144:159]
  v_mfma_f32_32x32x16_bf16 v[128:143], v[176:179], v[72:75], v[128:143]
  v_mfma_f32_32x32x16_bf16 v[144:159], v[180:183], v[72:75], v[144:159]
  v_mfma_f32_32x32x16_bf16 v[128:143], v[184:187], v[76:79], v[128:143]
  v_mfma_f32_32x32x16_bf16 v[144:159], v[188:191], v[76:79], v[144:159]
C_lw2:
  s_bitcmp1_b32 s47, s50
  s_cbranch_scc1 C_lr2
  ds_read_b32 v9, v8
  s_add_u32 s69, s69, 1
  s_waitcnt lgkmcnt(0)
  v_readfirstlane_b32 s47, v9
  s_nop 3
  s_or_b32 s47, s47, s51
  s_cmp_lt_u32 s69, 4000000
  s_cbranch_scc1 C_lw2
C_lr2:
  buffer_load_dwordx4 v[96:99], v2, s[36:39], s45 offen offset:0 sc1
  buffer_load_dwordx4 v[100:103], v2, s[36:39], s45 offen offset:1024 sc1
  buffer_load_dwordx4 v[104:107], v2, s[36:39], s45 offen offset:2048 sc1
  buffer_load_dwordx4 v[108:111], v2, s[36:39], s45 offen offset:3072 sc1
  s_add_u32 s45, s45, 4096
  s_add_u32 s50, s50, 1
  s_waitcnt vmcnt(4) lgkmcnt(0)
  v_mfma_f32_32x32x16_bf16 v[128:143], v[192:195], v[80:83], v[128:143]
  v_mfma_f32_32x32x16_bf16 v[144:159], v[196:199], v[80:83], v[144:159]
  v_mfma_f32_32x32x16_bf16 v[128:143], v[200:203], v[84:87], v[128:143]
  v_mfma_f32_32x32x16_bf16 v[144:159], v[204:207], v[84:87], v[144:159]
  v_mfma_f32_32x32x16_bf16 v[128:143], v[208:211], v[88:91], v[128:143]
  v_mfma_f32_32x32x16_bf16 v[144:159], v[212:215], v[88:91], v[144:159]
  v_mfma_f32_32x32x16_bf16 v[128:143], v[216:219], v[92:95], v[128:143]
  v_mfma_f32_32x32x16_bf16 v[144:159], v[220:223], v[92:95], v[144:159]
C_lw3:
  s_bitcmp1_b32 s47, s50
  s_cbranch_scc1 C_lr3
  ds_read_b32 v9, v8
  s_add_u32 s69, s69, 1
  s_waitcnt lgkmcnt(0)
  v_readfirstlane_b32 s47, v9
  s_nop 3
  s_or_b32 s47, s47, s51
  s_cmp_lt_u32 s69, 4000000
  s_cbranch_scc1 C_lw3
C_lr3:
  buffer_load_dwordx4 v[112:115], v2, s[36:39], s45 offen offset:0 sc1
  buffer_load_dwordx4 v[116:119], v2, s[36:39], s45 offen offset:1024 sc1
  buffer_load_dwordx4 v[120:123], v2, s[36:39], s45 offen offset:2048 sc1
  buffer_load_dwordx4 v[124:127], v2, s[36:39], s45 offen offset:3072 sc1
  s_add_u32 s45, s45, 4096
  s_add_u32 s50, s50, 1
  s_waitcnt vmcnt(4) lgkmcnt(0)
  v_mfma_f32_32x32x16_bf16 v[128:143], v[224:227], v[96:99], v[128:143]
  v_mfma_f32_32x32x16_bf16 v[144:159], v[228:231], v[96:99], v[144:159]
  v_mfma_f32_32x32x16_bf16 v[128:143], v[232:235], v[100:103], v[128:143]
  v_mfma_f32_32x32x16_bf16 v[144:159], v[236:239], v[100:103], v[144:159]
  v_mfma_f32_32x32x16_bf16 v[128:143], v[240:243], v[104:107], v[128:143]
  v_mfma_f32_32x32x16_bf16 v[144:159], v[244:247], v[104:107], v[144:159]
  v_mfma_f32_32x32x16_bf16 v[128:143], v[248:251], v[108:111], v[128:143]
  v_mfma_f32_32x32x16_bf16 v[144:159], v[252:255], v[108:111], v[144:159]
  s_branch C_go
C_poller:
  s_mov_b32 s52, 1
C_pw0:
  s_bitcmp1_b32 s47, s50
  s_cbranch_scc1 C_pr0
  s_mov_b64 exec, 0xffff
  buffer_load_dword v7, v6, s[36:39], s44 offen sc1
  s_mov_b64 exec, -1
  s_add_u32 s69, s69, 1
  s_waitcnt vmcnt(0)
  s_mov_b64 exec, 0xffff
  v_cmp_eq_u32 vcc, s68, v7
  s_mov_b64 exec, -1
  s_or_b32 s47, vcc_lo, s51
  v_mov_b32 v9, s47
  ds_write_b32 v8, v9
  s_cmp_lt_u32 s69, 200000
  s_cbranch_scc1 C_pw0
C_pr0:
  s_cmp_eq_u32 s47, 0xffff
  s_cbranch_scc1 C_pf0
  s_mov_b64 exec, 0xffff
  buffer_load_dword v7, v6, s[36:39], s44 offen sc1
  s_mov_b64 exec, -1
  buffer_load_dwordx4 v[64:67], v2, s[36:39], s45 offen offset:0 sc1
  buffer_load_dwordx4 v[68:71], v2, s[36:39], s45 offen offset:1024 sc1
  buffer_load_dwordx4 v[72:75], v2, s[36:39], s45 offen offset:2048 sc1
  buffer_load_dwordx4 v[76:79], v2, s[36:39], s45 offen offset:3072 sc1
  s_waitcnt vmcnt(4)
  s_mov_b64 exec, 0xffff
  v_cmp_eq_u32 vcc, s68, v7
  s_mov_b64 exec, -1
  s_or_b32 s47, vcc_lo, s51
  v_mov_b32 v9, s47
  ds_write_b32 v8, v9
  s_branch C_pn0
C_pf0:
  buffer_load_dwordx4 v[64:67], v2, s[36:39], s45 offen offset:0 sc1
  buffer_load_dwordx4 v[68:71], v2, s[36:39], s45 offen offset:1024 sc1
  buffer_load_dwordx4 v[72:75], v2, s[36:39], s45 offen offset:2048 sc1
  buffer_load_dwordx4 v[76:79], v2, s[36:39], s45 offen offset:3072 sc1
  s_waitcnt vmcnt(4)
C_pn0:
  s_add_u32 s45, s45, 4096
  s_add_u32 s50, s50, 1
  s_mov_b32 s52, 0
C_pw1:
  s_bitcmp1_b32 s47, s50
  s_cbranch_scc1 C_pr1
  s_mov_b64 exec, 0xffff
  buffer_load_dword v7, v6, s[36:39], s44 offen sc1
  s_mov_b64 exec, -1
  s_add_u32 s69, s69, 1
  s_waitcnt vmcnt(0)
  s_mov_b64 exec, 0xffff
  v_cmp_eq_u32 vcc, s68, v7
  s_mov_b64 exec, -1
  s_or_b32 s47, vcc_lo, s51
  v_mov_b32 v9, s47
  ds_write_b32 v8, v9
  s_cmp_lg_u32 s52, 0
  s_cbranch_scc1 C_pd1
  s_waitcnt lgkmcnt(0)
  v_mfma_f32_32x32x16_bf16 v[128:143], v[160:163], v[64:67], 0
  v_mfma_f32_32x32x16_bf16 v[144:159], v[164:167], v[64:67], 0
  v_mfma_f32_32x32x16_bf16 v[128:143], v[168:171], v[68:71], v[128:143]
  v_mfma_f32_32x32x16_bf16 v[144:159], v[172:175], v[68:71], v[144:159]
  v_mfma_f32_32x32x16_bf16 v[128:143], v[176:179], v[72:75], v[128:143]
  v_mfma_f32_32x32x16_bf16 v[144:159], v[180:183], v[72:75], v[144:159]
  v_mfma_f32_32x32x16_bf16 v[128:143], v[184:187], v[76:79], v[128:143]
  v_mfma_f32_32x32x16_bf16 v[144:159], v[188:191], v[76:79], v[144:159]
  s_mov_b32 s52, 1
C_pd1:
  s_cmp_lt_u32 s69, 200000
  s_cbranch_scc1 C_pw1
C_pr1:
  s_cmp_eq_u32 s47, 0xffff
  s_cbranch_scc1 C_pf1
  s_mov_b64 exec, 0xffff
  buffer_load_dword v7, v6, s[36:39], s44 offen sc1
  s_mov_b64 exec, -1
  buffer_load_dwordx4 v[80:83], v2, s[36:39], s45 offen offset:0 sc1
  buffer_load_dwordx4 v[84:87], v2, s[36:39], s45 offen offset:1024 sc1
  buffer_load_dwordx4 v[88:91], v2, s[36:39], s45 offen offset:2048 sc1
  buffer_load_dwordx4 v[92:95], v2, s[36:39], s45 offen offset:3072 sc1
  s_waitcnt vmcnt(4)
  s_mov_b64 exec, 0xffff
  v_cmp_eq_u32 vcc, s68, v7
  s_mov_b64 exec, -1
  s_or_b32 s47, vcc_lo, s51
  v_mov_b32 v9, s47
  ds_write_b32 v8, v9
  s_branch C_pn1
C_pf1:
  buffer_load_dwordx4 v[80:83], v2, s[36:39], s45 offen offset:0 sc1
  buffer_load_dwordx4 v[84:87], v2, s[36:39], s45 offen offset:1024 sc1
  buffer_load_dwordx4 v[88:91], v2, s[36:39], s45 offen offset:2048 sc1
  buffer_load_dwordx4 v[92:95], v2, s[36:39], s45 offen offset:3072 sc1
  s_waitcnt vmcnt(4)
C_pn1:
  s_cmp_lg_u32 s52, 0
  s_cbranch_scc1 C_pe1
  s_waitcnt lgkmcnt(0)
  v_mfma_f32_32x32x16_bf16 v[128:143], v[160:163], v[64:67], 0
  v_mfma_f32_32x32x16_bf16 v[144:159], v[164:167], v[64:67], 0
  v_mfma_f32_32x32x16_bf16 v[128:143], v[168:171], v[68:71], v[128:143]
  v_mfma_f32_32x32x16_bf16 v[144:159], v[172:175], v[68:71], v[144:159]
  v_mfma_f32_32x32x16_bf16 v[128:143], v[176:179], v[72:75], v[128:143]
  v_mfma_f32_32x32x16_bf16 v[144:159], v[180:183], v[72:75], v[144:159]
  v_mfma_f32_32x32x16_bf16 v[128:143], v[184:187], v[76:79], v[128:143]
  v_mfma_f32_32x32x16_bf16 v[144:159], v[188:191], v[76:79], v[144:159]
C_pe1:
  s_add_u32 s45, s45, 4096
  s_add_u32 s50, s50, 1
  s_mov_b32 s52, 0
C_pw2:
  s_bitcmp1_b32 s47, s50
  s_cbranch_scc1 C_pr2
  s_mov_b64 exec, 0xffff
  buffer_load_dword v7, v6, s[36:39], s44 offen sc1
  s_mov_b64 exec, -1
  s_add_u32 s69, s69, 1
  s_waitcnt vmcnt(0)
  s_mov_b64 exec, 0xffff
  v_cmp_eq_u32 vcc, s68, v7
  s_mov_b64 exec, -1
  s_or_b32 s47, vcc_lo, s51
  v_mov_b32 v9, s47
  ds_write_b32 v8, v9
  s_cmp_lg_u32 s52, 0
  s_cbranch_scc1 C_pd2
  s_waitcnt lgkmcnt(0)
  v_mfma_f32_32x32x16_bf16 v[128:143], v[192:195], v[80:83], v[128:143]
  v_mfma_f32_32x32x16_bf16 v[144:159], v[196:199], v[80:83], v[144:159]
  v_mfma_f32_32x32x16_bf16 v[128:143], v[200:203], v[84:87], v[128:143]
  v_mfma_f32_32x32x16_bf16 v[144:159], v[204:207], v[84:87], v[144:159]
  v_mfma_f32_32x32x16_bf16 v[128:143], v[208:211], v[88:91], v[128:143]
  v_mfma_f32_32x32x16_bf16 v[144:159], v[212:215], v[88:91], v[144:159]
  v_mfma_f32_32x32x16_bf16 v[128:143], v[216:219], v[92:95], v[128:143]
  v_mfma_f32_32x32x16_bf16 v[144:159], v[220:223], v[92:95], v[144:159]
  s_mov_b32 s52, 1
C_pd2:
  s_cmp_lt_u32 s69, 200000
  s_cbranch_scc1 C_pw2
C_pr2:
  s_cmp_eq_u32 s47, 0xffff
  s_cbranch_scc1 C_pf2
  s_mov_b64 exec, 0xffff
  buffer_load_dword v7, v6, s[36:39], s44 offen sc1
  s_mov_b64 exec, -1
  buffer_load_dwordx4 v[96:99], v2, s[36:39], s45 offen offset:0 sc1
  buffer_load_dwordx4 v[100:103], v2, s[36:39], s45 offen offset:1024 sc1
  buffer_load_dwordx4 v[104:107], v2, s[36:39], s45 offen offset:2048 sc1
  buffer_load_dwordx4 v[108:111], v2, s[36:39], s45 offen offset:3072 sc1
  s_waitcnt vmcnt(4)
  s_mov_b64 exec, 0xffff
  v_cmp_eq_u32 vcc, s68, v7
  s_mov_b64 exec, -1
  s_or_b32 s47, vcc_lo, s51
  v_mov_b32 v9, s47
  ds_write_b32 v8, v9
  s_branch C_pn2
C_pf2:
  buffer_load_dwordx4 v[96:99], v2, s[36:39], s45 offen offset:0 sc1
  buffer_load_dwordx4 v[100:103], v2, s[36:39], s45 offen offset:1024 sc1
  buffer_load_dwordx4 v[104:107], v2, s[36:39], s45 offen offset:2048 sc1
  buffer_load_dwordx4 v[108:111], v2, s[36:39], s45 offen offset:3072 sc1
  s_waitcnt vmcnt(4)
C_pn2:
  s_cmp_lg_u32 s52, 0
  s_cbranch_scc1 C_pe2
  s_waitcnt lgkmcnt(0)
  v_mfma_f32_32x32x16_bf16 v[128:143], v[192:195], v[80:83], v[128:143]
  v_mfma_f32_32x32x16_bf16 v[144:159], v[196:199], v[80:83], v[144:159]
  v_mfma_f32_32x32x16_bf16 v[128:143], v[200:203], v[84:87], v[128:143]
  v_mfma_f32_32x32x16_bf16 v[144:159], v[204:207], v[84:87], v[144:159]
  v_mfma_f32_32x32x16_bf16 v[128:143], v[208:211], v[88:91], v[128:143]
  v_mfma_f32_32x32x16_bf16 v[144:159], v[212:215], v[88:91], v[144:159]
  v_mfma_f32_32x32x16_bf16 v[128:143], v[216:219], v[92:95], v[128:143]
  v_mfma_f32_32x32x16_bf16 v[144:159], v[220:223], v[92:95], v[144:159]
C_pe2:
  s_add_u32 s45, s45, 4096
  s_add_u32 s50, s50, 1
  s_mov_b32 s52, 0
C_pw3:
  s_bitcmp1_b32 s47, s50
  s_cbranch_scc1 C_pr3
  s_mov_b64 exec, 0xffff
  buffer_load_dword v7, v6, s[36:39], s44 offen sc1
  s_mov_b64 exec, -1
  s_add_u32 s69, s69, 1
  s_waitcnt vmcnt(0)
  s_mov_b64 exec, 0xffff
  v_cmp_eq_u32 vcc, s68, v7
  s_mov_b64 exec, -1
  s_or_b32 s47, vcc_lo, s51
  v_mov_b32 v9, s47
  ds_write_b32 v8, v9
  s_cmp_lg_u32 s52, 0
  s_cbranch_scc1 C_pd3
  s_waitcnt lgkmcnt(0)
  v_mfma_f32_32x32x16_bf16 v[128:143], v[224:227], v[96:99], v[128:143]
  v_mfma_f32_32x32x16_bf16 v[144:159], v[228:231], v[96:99], v[144:159]
  v_mfma_f32_32x32x16_bf16 v[128:143], v[232:235], v[100:103], v[128:143]
  v_mfma_f32_32x32x16_bf16 v[144:159], v[236:239], v[100:103], v[144:159]
  v_mfma_f32_32x32x16_bf16 v[128:143], v[240:243], v[104:107], v[128:143]
  v_mfma_f32_32x32x16_bf16 v[144:159], v[244:247], v[104:107], v[144:159]
  v_mfma_f32_32x32x16_bf16 v[128:143], v[248:251], v[108:111], v[128:143]
  v_mfma_f32_32x32x16_bf16 v[144:159], v[252:255], v[108:111], v[144:159]
  s_mov_b32 s52, 1
C_pd3:
  s_cmp_lt_u32 s69, 200000
  s_cbranch_scc1 C_pw3
C_pr3:
  s_cmp_eq_u32 s47, 0xffff
  s_cbranch_scc1 C_pf3
  s_mov_b64 exec, 0xffff
  buffer_load_dword v7, v6, s[36:39], s44 offen sc1
  s_mov_b64 exec, -1
  buffer_load_dwordx4 v[112:115], v2, s[36:39], s45 offen offset:0 sc1
  buffer_load_dwordx4 v[116:119], v2, s[36:39], s45 offen offset:1024 sc1
  buffer_load_dwordx4 v[120:123], v2, s[36:39], s45 offen offset:2048 sc1
  buffer_load_dwordx4 v[124:127], v2, s[36:39], s45 offen offset:3072 sc1
  s_waitcnt vmcnt(4)
  s_mov_b64 exec, 0xffff
  v_cmp_eq_u32 vcc, s68, v7
  s_mov_b64 exec, -1
  s_or_b32 s47, vcc_lo, s51
  v_mov_b32 v9, s47
  ds_write_b32 v8, v9
  s_branch C_pn3
C_pf3:
  buffer_load_dwordx4 v[112:115], v2, s[36:39], s45 offen offset:0 sc1
  buffer_load_dwordx4 v[116:119], v2, s[36:39], s45 offen offset:1024 sc1
  buffer_load_dwordx4 v[120:123], v2, s[36:39], s45 offen offset:2048 sc1
  buffer_load_dwordx4 v[124:127], v2, s[36:39], s45 offen offset:3072 sc1
  s_waitcnt vmcnt(4)
C_pn3:
  s_cmp_lg_u32 s52, 0
  s_cbranch_scc1 C_pe3
  s_waitcnt lgkmcnt(0)
  v_mfma_f32_32x32x16_bf16 v[128:143], v[224:227], v[96:99], v[128:143]
  v_mfma_f32_32x32x16_bf16 v[144:159], v[228:231], v[96:99], v[144:159]
  v_mfma_f32_32x32x16_bf16 v[128:143], v[232:235], v[100:103], v[128:143]
  v_mfma_f32_32x32x16_bf16 v[144:159], v[236:239], v[100:103], v[144:159]
  v_mfma_f32_32x32x16_bf16 v[128:143], v[240:243], v[104:107], v[128:143]
  v_mfma_f32_32x32x16_bf16 v[144:159], v[244:247], v[104:107], v[144:159]
  v_mfma_f32_32x32x16_bf16 v[128:143], v[248:251], v[108:111], v[128:143]
  v_mfma_f32_32x32x16_bf16 v[144:159], v[252:255], v[108:111], v[144:159]
C_pe3:
  s_add_u32 s45, s45, 4096
  s_add_u32 s50, s50, 1
C_pw4:
  s_cmp_eq_u32 s47, 0xffff
  s_cbranch_scc1 C_go
  s_mov_b64 exec, 0xffff
  buffer_load_dword v7, v6, s[36:39], s44 offen sc1
  s_mov_b64 exec, -1
  s_add_u32 s69, s69, 1
  s_waitcnt vmcnt(0)
  s_mov_b64 exec, 0xffff
  v_cmp_eq_u32 vcc, s68, v7
  s_mov_b64 exec, -1
  s_or_b32 s47, vcc_lo, s51
  v_mov_b32 v9, s47
  ds_write_b32 v8, v9
  s_cmp_lt_u32 s69, 200000
  s_cbranch_scc1 C_pw4
C_go:
  s_waitcnt vmcnt(0) lgkmcnt(0)
  v_mfma_f32_32x32x16_bf16 v[128:143], v[32:35], v[112:115], v[128:143]
  v_mfma_f32_32x32x16_bf16 v[144:159], v[36:39], v[112:115], v[144:159]
  v_mfma_f32_32x32x16_bf16 v[128:143], v[40:43], v[116:119], v[128:143]
  v_mfma_f32_32x32x16_bf16 v[144:159], v[44:47], v[116:119], v[144:159]
  v_mfma_f32_32x32x16_bf16 v[128:143], v[48:51], v[120:123], v[128:143]
  v_mfma_f32_32x32x16_bf16 v[144:159], v[52:55], v[120:123], v[144:159]
  v_mfma_f32_32x32x16_bf16 v[128:143], v[56:59], v[124:127], v[128:143]
  v_mfma_f32_32x32x16_bf16 v[144:159], v[60:63], v[124:127], v[144:159]
  s_barrier
  s_nop 7
  s_nop 3
  ds_write_b128 v10, v[128:131]
  ds_write_b128 v11, v[132:135]
  ds_write_b128 v12, v[136:139]
  ds_write_b128 v13, v[140:143]
  ds_write_b128 v14, v[144:147]
  ds_write_b128 v15, v[148:151]
  ds_write_b128 v16, v[152:155]
  ds_write_b128 v17, v[156:159]
  s_waitcnt lgkmcnt(0)
  s_barrier
  ds_read_b128 v[64:67], v18 offset:0
  ds_read_b128 v[72:75], v18 offset:16384
  ds_read_b128 v[80:83], v18 offset:32768
  ds_read_b128 v[88:91], v18 offset:49152
  ds_read_b128 v[68:71], v19 offset:0
  ds_read_b128 v[76:79], v19 offset:16384
  ds_read_b128 v[84:87], v19 offset:32768
  ds_read_b128 v[92:95], v19 offset:49152
  s_waitcnt lgkmcnt(0)
  v_pk_add_f32 v[64:65], v[64:65], v[72:73]
  v_pk_add_f32 v[80:81], v[80:81], v[88:89]
  v_pk_add_f32 v[66:67], v[66:67], v[74:75]
  v_pk_add_f32 v[82:83], v[82:83], v[90:91]
  v_pk_add_f32 v[68:69], v[68:69], v[76:77]
  v_pk_add_f32 v[84:85], v[84:85], v[92:93]
  v_pk_add_f32 v[70:71], v[70:71], v[78:79]
  v_pk_add_f32 v[86:87], v[86:87], v[94:95]
  v_pk_add_f32 v[64:65], v[64:65], v[80:81]
  v_pk_add_f32 v[66:67], v[66:67], v[82:83]
  v_pk_add_f32 v[68:69], v[68:69], v[84:85]
  v_pk_add_f32 v[70:71], v[70:71], v[86:87]
  v_cvt_pk_bf16_f32 v64, v64, v65
  v_cvt_pk_bf16_f32 v65, v66, v67
  v_cvt_pk_bf16_f32 v66, v68, v69
  v_cvt_pk_bf16_f32 v67, v70, v71
  buffer_store_dwordx4 v[64:67], v22, s[60:63], s48 offen sc1
L_end:
  s_endpgm
L_codeend:
.section .rodata,"a"
.p2align 6
.amdhsa_kernel gated_mix__mha_block__mha_block__prompt_kernel
  .amdhsa_next_free_vgpr 256
  .amdhsa_next_free_sgpr 102
  .amdhsa_accum_offset 256
  .amdhsa_group_segment_fixed_size 0
  .amdhsa_kernarg_size 80
  .amdhsa_user_sgpr_count 2
  .amdhsa_user_sgpr_kernarg_segment_ptr 1
  .amdhsa_system_sgpr_workgroup_id_x 1
.end_amdhsa_kernel
```
